```python
import torch

def _softmax(x, axis=-1):
    return torch.softmax(x, dim=axis)
def _gelu(x):
    return torch.nn.functional.gelu(x, approximate="tanh")
def _silu(x):
    return torch.nn.functional.silu(x)
def _sigmoid(x):
    return torch.sigmoid(x)
def _layernorm(x, axis=-1, eps=1e-5):
    m = x.mean(dim=axis, keepdim=True)
    v = x.var(dim=axis, keepdim=True, unbiased=False)
    return (x - m) / torch.sqrt(v + eps)
def _scatter_add(tgt, idx, src, axis=0):
    return tgt.clone().index_add_(axis, idx, src)
def _segment_sum(src, seg, n):
    out = torch.zeros((n,) + src.shape[1:], dtype=src.dtype)
    return out.index_add_(0, seg, src)
def _pad(x, pw):
    flat = tuple(v for pair in reversed(pw) for v in pair)
    return torch.nn.functional.pad(x, flat)

kernel_name = 'concat_heads__sliding_block_cached__gqa_block_cached__decode'

def setup_inputs():

    _w = (lambda a: (lambda t: t.to(torch.bfloat16) if t.is_floating_point() else t)(torch.as_tensor(a)))
    def _A_setup():
        B, Sq, D = 1, 1, 576
        Hq, Hkv, Sk, Dh = 32, 16, 8192, 128
        assert Hq % Hkv == 0, (Hq, Hkv)
        return {
            "x": _w((lambda *s: torch.randn(*s, dtype=torch.bfloat16) * 0.8)(B, Sq, D)),
            "k_cache": _w((lambda *s: torch.randn(*s, dtype=torch.bfloat16) * 1.6)(B, Hkv, Sk, Dh)),
            "v_cache": _w((lambda *s: torch.randn(*s, dtype=torch.bfloat16) * 0.2)(B, Hkv, Sk, Dh)),
            "wq": _w((lambda *s: torch.randn(*s, dtype=torch.bfloat16) * 1.6)(D, Hq * Dh) * (D ** -0.5)),
            "wo": _w((lambda *s: torch.randn(*s, dtype=torch.bfloat16) * 0.2)(Hq * Dh, D) * ((Hq * Dh) ** -0.5)),
        }
    _A_in = _A_setup()

    def _B_setup():
        B, Sq, D = 1, 1, 576
        Hq, Hkv, Sk, Dh = 32, 16, 8192, 128
        assert Hq % Hkv == 0, (Hq, Hkv)
        return {
            "x": _w((lambda *s: torch.randn(*s, dtype=torch.bfloat16) * 0.8)(B, Sq, D)),
            "k_cache": _w((lambda *s: torch.randn(*s, dtype=torch.bfloat16) * 1.6)(B, Hkv, Sk, Dh)),
            "v_cache": _w((lambda *s: torch.randn(*s, dtype=torch.bfloat16) * 0.2)(B, Hkv, Sk, Dh)),
            "wq": _w((lambda *s: torch.randn(*s, dtype=torch.bfloat16) * 1.6)(D, Hq * Dh) * (D ** -0.5)),
            "wo": _w((lambda *s: torch.randn(*s, dtype=torch.bfloat16) * 0.2)(Hq * Dh, D) * ((Hq * Dh) ** -0.5)),
        }
    _B_in = _B_setup()

    return {
        "A_x": _A_in["x"],
        "A_k_cache": _A_in["k_cache"],
        "A_v_cache": _A_in["v_cache"],
        "A_wq": _A_in["wq"],
        "A_wo": _A_in["wo"],
        "B_x": _B_in["x"],
        "B_k_cache": _B_in["k_cache"],
        "B_v_cache": _B_in["v_cache"],
        "B_wq": _B_in["wq"],
        "B_wo": _B_in["wo"],
    }

def reference(A_x, A_k_cache, A_v_cache, A_wq, A_wo, B_x, B_k_cache, B_v_cache, B_wq, B_wo):
    def _A_ref(x, k_cache, v_cache, wq, wo):
        B, Sq, D = x.shape
        Hq, Dh = 32, 128
        Hkv, Sk = k_cache.shape[1], k_cache.shape[2]
        W = min(4096, max(256, Sk // 4))
        rep = Hq // Hkv
        q = (lambda x, *d: x.permute(*d))((x @ wq).reshape(B, Sq, Hq, Dh), 0, 2, 1, 3)
        k = (lambda x, n, axis: torch.repeat_interleave(x, n, dim=axis))(k_cache[:, :, Sk - W:, :], rep, axis=1)
        v = (lambda x, n, axis: torch.repeat_interleave(x, n, dim=axis))(v_cache[:, :, Sk - W:, :], rep, axis=1)
        scores = torch.einsum("bhqd,bhkd->bhqk", q, k) * (Dh ** -0.5)
        p = _softmax(scores, axis=-1)
        o = torch.einsum("bhqk,bhkd->bhqd", p, v)
        return (lambda x, *d: x.permute(*d))(o, 0, 2, 1, 3).reshape(B, Sq, Hq * Dh) @ wo

    def _B_ref(x, k_cache, v_cache, wq, wo):
        B, Sq, D = x.shape
        Hq, Dh = 32, 128
        Hkv = k_cache.shape[1]
        rep = Hq // Hkv
        q = (lambda x, *d: x.permute(*d))((x @ wq).reshape(B, Sq, Hq, Dh), 0, 2, 1, 3)
        k = (lambda x, n, axis: torch.repeat_interleave(x, n, dim=axis))(k_cache, rep, axis=1)
        v = (lambda x, n, axis: torch.repeat_interleave(x, n, dim=axis))(v_cache, rep, axis=1)
        scores = torch.einsum("bhqd,bhkd->bhqk", q, k) * (Dh ** -0.5)
        p = _softmax(scores, axis=-1)
        o = torch.einsum("bhqk,bhkd->bhqd", p, v)
        return (lambda x, *d: x.permute(*d))(o, 0, 2, 1, 3).reshape(B, Sq, Hq * Dh) @ wo

    a = _A_ref(A_x, A_k_cache, A_v_cache, A_wq, A_wo)
    b = _B_ref(B_x, B_k_cache, B_v_cache, B_wq, B_wo)
    return torch.concatenate([a, b], axis=-1)
```

```asm
; @launch grid=(256,1,1) block=(512,1,1) lds=6720
.amdgcn_target "amdgcn-amd-amdhsa--gfx950"
.text
.globl concat_heads__sliding_block_cached__gqa_block_cached__decode_kernel
.p2align 8
.type concat_heads__sliding_block_cached__gqa_block_cached__decode_kernel,@function
concat_heads__sliding_block_cached__gqa_block_cached__decode_kernel:
    s_load_dwordx16 s[16:31], s[0:1], 0
    s_load_dwordx8 s[32:39], s[0:1], 64
    s_load_dwordx2 s[40:41], s[0:1], 96
    v_lshrrev_b32 v1, 6, v0
    s_lshr_b32 s7, s2, 8
    s_cbranch_scc1 L_end
    v_readfirstlane_b32 s3, v1
    s_lshr_b32 s5, s2, 7
    s_and_b32 s4, s2, 7
    s_lshl1_add_u32 s4, s4, s5
    s_bfe_u32 s5, s2, 0x40003
    s_mov_b32 s47, 0x20000
    s_cmp_gt_u32 s3, 3
    s_cbranch_scc1 L_stream
    v_bfe_u32 v9, v0, 3, 3
    v_and_b32 v10, 7, v0
    v_mul_u32_u24 v11, 0x18000, v9
    v_lshl_add_u32 v11, v10, 4, v11
    s_lshl2_add_u32 s10, s4, s3
    s_lshl_b32 s10, s10, 7
    s_cmp_gt_u32 s5, 5
    s_cselect_b32 s9, 6, 0
    s_sub_u32 s9, s5, s9
    s_mul_i32 s11, s9, 0xc0000
    v_add_u32 v11, s11, v11
    s_movk_i32 s12, 0x2000
    s_mov_b32 s46, 0x480000
    s_cmp_gt_u32 s5, 5
    s_waitcnt lgkmcnt(0)
    s_cselect_b64 s[44:45], s[32:33], s[22:23]
    s_cselect_b64 s[48:49], s[26:27], s[16:17]
    buffer_load_dwordx4 v[20:23], v11, s[44:47], s10 offen nt
    s_add_u32 s10, s10, s12
    buffer_load_dwordx4 v[24:27], v11, s[44:47], s10 offen nt
    s_add_u32 s10, s10, s12
    buffer_load_dwordx4 v[28:31], v11, s[44:47], s10 offen nt
    s_add_u32 s10, s10, s12
    buffer_load_dwordx4 v[32:35], v11, s[44:47], s10 offen nt
    s_add_u32 s10, s10, s12
    buffer_load_dwordx4 v[36:39], v11, s[44:47], s10 offen nt
    s_add_u32 s10, s10, s12
    buffer_load_dwordx4 v[40:43], v11, s[44:47], s10 offen nt
    s_add_u32 s10, s10, s12
    buffer_load_dwordx4 v[44:47], v11, s[44:47], s10 offen nt
    s_add_u32 s10, s10, s12
    buffer_load_dwordx4 v[48:51], v11, s[44:47], s10 offen nt
    s_add_u32 s10, s10, s12
    s_movk_i32 s50, 1152
    s_mov_b32 s51, 0x20000
    s_mul_i32 s11, s9, 192
    v_mul_u32_u24 v18, 24, v9
    v_add_u32 v18, s11, v18
    buffer_load_dwordx4 v[12:15], v18, s[48:51], 0 offen
    buffer_load_dwordx2 v[16:17], v18, s[48:51], 0 offen offset:16
    buffer_load_dwordx4 v[52:55], v11, s[44:47], s10 offen nt
    s_add_u32 s10, s10, s12
    buffer_load_dwordx4 v[56:59], v11, s[44:47], s10 offen nt
    s_add_u32 s10, s10, s12
    buffer_load_dwordx4 v[60:63], v11, s[44:47], s10 offen nt
    s_add_u32 s10, s10, s12
    buffer_load_dwordx4 v[64:67], v11, s[44:47], s10 offen nt
    s_branch L_help2
L_stream:
    s_sub_u32 s9, s3, 4
    s_mul_i32 s14, s5, 156
    s_cmp_eq_u32 s5, 11
    s_cselect_b32 s15, 4, 3
    s_cmp_gt_u32 s5, 11
    s_cselect_b32 s15, 7, s15
    s_cselect_b32 s14, 1876, s14
    s_cmp_eq_u32 s5, 15
    s_cselect_b32 s15, 6, s15
    s_mul_i32 s10, s5, 172
    s_sub_u32 s10, s10, 700
    s_cmp_gt_u32 s5, 12
    s_cselect_b32 s14, s10, s14
    s_lshl_b32 s10, s4, 11
    s_add_u32 s14, s14, s10
    s_lshl_b32 s14, s14, 10
    s_mul_i32 s11, s9, s15
    s_add_u32 s11, s11, 144
    s_add_u32 s46, s11, s15
    s_lshl_b32 s46, s46, 10
    s_lshl_b32 s11, s11, 10
    s_lshl_b32 s10, s9, 12
    s_movk_i32 s13, 16384
    v_bfe_u32 v8, v0, 2, 2
    v_lshlrev_b32 v8, 8, v8
    v_bfe_u32 v1, v0, 4, 2
    v_lshl_add_u32 v8, v1, 6, v8
    v_and_b32 v10, 3, v0
    v_lshl_add_u32 v255, v10, 4, v8
    v_add_u32 v9, s10, v255
    s_cmp_lt_u32 s5, 13
    s_waitcnt lgkmcnt(0)
    s_cselect_b64 s[44:45], s[28:29], s[18:19]
    s_cselect_b64 s[48:49], s[30:31], s[20:21]
    s_add_u32 s44, s44, s14
    s_addc_u32 s45, s45, 0
    buffer_load_dwordx4 v[12:15], v9, s[44:47], 0 offen offset:0 nt
    buffer_load_dwordx4 v[16:19], v9, s[44:47], 0 offen offset:1024 nt
    buffer_load_dwordx4 v[20:23], v9, s[44:47], 0 offen offset:2048 nt
    buffer_load_dwordx4 v[24:27], v9, s[44:47], 0 offen offset:3072 nt
    v_add_u32 v9, s13, v9
    buffer_load_dwordx4 v[28:31], v9, s[44:47], 0 offen offset:0 nt
    buffer_load_dwordx4 v[32:35], v9, s[44:47], 0 offen offset:1024 nt
    buffer_load_dwordx4 v[36:39], v9, s[44:47], 0 offen offset:2048 nt
    buffer_load_dwordx4 v[40:43], v9, s[44:47], 0 offen offset:3072 nt
    v_add_u32 v9, s13, v9
    s_branch L_stream2
L_help2:
    v_mov_b32 v121, 0
    v_mov_b32 v122, 0
    v_mov_b32 v123, 0
    ds_write_b64 v121, v[122:123] offset:6656
    ds_write_b64 v121, v[122:123] offset:6664
    ds_write_b64 v121, v[122:123] offset:6672
    ds_write_b64 v121, v[122:123] offset:6680
    s_waitcnt lgkmcnt(0)
    s_barrier
    v_mov_b32 v122, 1
    s_load_dword s42, s[40:41], 0
    v_and_b32 v0, 63, v0
    v_lshrrev_b32 v1, 4, v0
    v_and_b32 v2, 15, v0
    v_lshlrev_b32 v3, 4, v0
    s_lshl4_add_u32 s6, s4, s5
    s_mul_i32 s8, s6, 4352
    s_add_u32 s8, s8, 270336
    s_mov_b32 s52, s40
    s_mov_b32 s53, s41
    s_mov_b32 s54, 16777216
    s_mov_b32 s55, 0x20000
    v_and_b32 v8, 1, v0
    v_lshlrev_b32 v8, 4, v8
    v_mov_b32 v7, 0xffff
    v_lshlrev_b32 v8, v8, v7
    v_bfe_u32 v7, v0, 1, 2
    v_cmp_eq_u32 vcc, 0, v7
    s_nop 1
    v_cndmask_b32 v4, 0, v8, vcc
    v_cmp_eq_u32 vcc, 1, v7
    s_nop 1
    v_cndmask_b32 v5, 0, v8, vcc
    v_cmp_eq_u32 vcc, 2, v7
    s_nop 1
    v_cndmask_b32 v6, 0, v8, vcc
    v_cmp_eq_u32 vcc, 3, v7
    s_nop 1
    v_cndmask_b32 v7, 0, v8, vcc
    v_mov_b32 v19, 0xffffff00
    v_lshlrev_b32 v120, 4, v2
    v_lshl_add_u32 v120, v1, 7, v120
    s_lshl_b32 s13, s3, 8
    s_cmp_gt_u32 s5, 11
    s_cbranch_scc1 L_noq
    s_mov_b32 s11, 0x01000100
    s_mov_b32 s12, 0x03020302
    s_lshl_b32 s10, s6, 10
    s_add_u32 s10, s10, s13
    s_add_u32 s10, s10, 8192
    s_waitcnt vmcnt(0)
    v_perm_b32 v18, v12, v12, s11
    v_and_b32 v68, v18, v4
    v_and_b32 v69, v18, v5
    v_and_b32 v70, v18, v6
    v_and_b32 v71, v18, v7
    v_perm_b32 v18, v12, v12, s12
    v_and_b32 v72, v18, v4
    v_and_b32 v73, v18, v5
    v_and_b32 v74, v18, v6
    v_and_b32 v75, v18, v7
    v_mfma_f32_16x16x32_bf16 v[116:119], v[68:71], v[20:23], 0
    v_perm_b32 v18, v13, v13, s11
    v_and_b32 v76, v18, v4
    v_and_b32 v77, v18, v5
    v_and_b32 v78, v18, v6
    v_and_b32 v79, v18, v7
    v_mfma_f32_16x16x32_bf16 v[116:119], v[72:75], v[24:27], v[116:119]
    v_perm_b32 v18, v13, v13, s12
    v_and_b32 v80, v18, v4
    v_and_b32 v81, v18, v5
    v_and_b32 v82, v18, v6
    v_and_b32 v83, v18, v7
    v_mfma_f32_16x16x32_bf16 v[116:119], v[76:79], v[28:31], v[116:119]
    v_perm_b32 v18, v14, v14, s11
    v_and_b32 v84, v18, v4
    v_and_b32 v85, v18, v5
    v_and_b32 v86, v18, v6
    v_and_b32 v87, v18, v7
    v_mfma_f32_16x16x32_bf16 v[116:119], v[80:83], v[32:35], v[116:119]
    v_perm_b32 v18, v14, v14, s12
    v_and_b32 v88, v18, v4
    v_and_b32 v89, v18, v5
    v_and_b32 v90, v18, v6
    v_and_b32 v91, v18, v7
    v_mfma_f32_16x16x32_bf16 v[116:119], v[84:87], v[36:39], v[116:119]
    v_perm_b32 v18, v15, v15, s11
    v_and_b32 v92, v18, v4
    v_and_b32 v93, v18, v5
    v_and_b32 v94, v18, v6
    v_and_b32 v95, v18, v7
    v_mfma_f32_16x16x32_bf16 v[116:119], v[88:91], v[40:43], v[116:119]
    v_perm_b32 v18, v15, v15, s12
    v_and_b32 v96, v18, v4
    v_and_b32 v97, v18, v5
    v_and_b32 v98, v18, v6
    v_and_b32 v99, v18, v7
    v_mfma_f32_16x16x32_bf16 v[116:119], v[92:95], v[44:47], v[116:119]
    v_perm_b32 v18, v16, v16, s11
    v_and_b32 v100, v18, v4
    v_and_b32 v101, v18, v5
    v_and_b32 v102, v18, v6
    v_and_b32 v103, v18, v7
    v_mfma_f32_16x16x32_bf16 v[116:119], v[96:99], v[48:51], v[116:119]
    v_perm_b32 v18, v16, v16, s12
    v_and_b32 v104, v18, v4
    v_and_b32 v105, v18, v5
    v_and_b32 v106, v18, v6
    v_and_b32 v107, v18, v7
    v_mfma_f32_16x16x32_bf16 v[116:119], v[100:103], v[52:55], v[116:119]
    v_perm_b32 v18, v17, v17, s11
    v_and_b32 v108, v18, v4
    v_and_b32 v109, v18, v5
    v_and_b32 v110, v18, v6
    v_and_b32 v111, v18, v7
    v_mfma_f32_16x16x32_bf16 v[116:119], v[104:107], v[56:59], v[116:119]
    v_perm_b32 v18, v17, v17, s12
    v_and_b32 v112, v18, v4
    v_and_b32 v113, v18, v5
    v_and_b32 v114, v18, v6
    v_and_b32 v115, v18, v7
    v_mfma_f32_16x16x32_bf16 v[116:119], v[108:111], v[60:63], v[116:119]
    s_nop 0
    v_mfma_f32_16x16x32_bf16 v[116:119], v[112:115], v[64:67], v[116:119]
    s_waitcnt lgkmcnt(0)
    s_add_u32 s43, s42, 1
    s_and_b32 s42, s43, 0xff
    s_lshr_b32 s93, s43, 8
    s_lshr_b32 s94, s43, 16
    s_lshr_b32 s95, s43, 24
    s_add_u32 s93, s93, s42
    s_add_u32 s94, s94, s42
    s_add_u32 s95, s95, s42
    s_and_b32 s93, s93, 0xff
    s_and_b32 s94, s94, 0xff
    s_and_b32 s95, s95, 0xff
    v_permlane32_swap_b32 v116, v124
    v_permlane32_swap_b32 v117, v125
    v_permlane32_swap_b32 v118, v126
    v_permlane32_swap_b32 v119, v127
    v_add_f32_dpp v116, v124, v116 row_ror:8 row_mask:0xf bank_mask:0xf
    v_add_f32_dpp v117, v125, v117 row_ror:8 row_mask:0xf bank_mask:0xf
    v_add_f32_dpp v118, v126, v118 row_ror:8 row_mask:0xf bank_mask:0xf
    v_add_f32_dpp v119, v127, v119 row_ror:8 row_mask:0xf bank_mask:0xf
    v_and_or_b32 v116, v116, v19, s42
    v_and_or_b32 v117, v117, v19, s93
    v_and_or_b32 v118, v118, v19, s94
    v_and_or_b32 v119, v119, v19, s95
    s_mov_b64 exec, 0x00ff00ff
    buffer_store_dwordx4 v[116:119], v120, s[52:55], s10 offen
    s_mov_b64 exec, -1
    s_add_u32 s15, s10, 2097152
    s_branch L_qgather
L_noq:
    s_mov_b32 s15, 0
    v_mov_b32 v120, 16777216
    s_waitcnt lgkmcnt(0)
    s_add_u32 s43, s42, 1
    s_and_b32 s42, s43, 0xff
    s_lshr_b32 s93, s43, 8
    s_lshr_b32 s94, s43, 16
    s_lshr_b32 s95, s43, 24
    s_add_u32 s93, s93, s42
    s_add_u32 s94, s94, s42
    s_add_u32 s95, s95, s42
    s_and_b32 s93, s93, 0xff
    s_and_b32 s94, s94, 0xff
    s_and_b32 s95, s95, 0xff
L_qgather:
    s_getreg_b32 s84, hwreg(HW_REG_XCC_ID, 0, 4)
    s_lshl4_add_u32 s84, s43, s84
    s_lshl_b32 s85, s4, 8
    s_add_u32 s85, s85, 4096
    v_lshlrev_b32 v101, 4, v2
    s_cmp_eq_u32 s3, 0
    s_cbranch_scc0 L_nohello
    s_lshl4_add_u32 s86, s5, s85
    v_mov_b32 v104, s84
    v_mov_b32 v105, s84
    v_mov_b32 v106, s84
    v_mov_b32 v107, s84
    s_mov_b64 exec, 1
    buffer_store_dwordx4 v[104:107], v121, s[52:55], s86 offen
    s_mov_b64 exec, -1
L_nohello:
    s_cmp_lt_u32 s5, 13
    s_cselect_b32 s10, 6, 0
    s_lshl4_add_u32 s10, s4, s10
    s_lshl_b32 s10, s10, 10
    s_add_u32 s10, s10, s13
    s_add_u32 s10, s10, 8192
    s_add_u32 s11, s10, 4096
    v_lshlrev_b32 v96, 10, v1
    v_lshl_add_u32 v96, v2, 4, v96
    v_lshrrev_b32 v97, 1, v1
    v_and_b32 v98, 1, v1
    v_lshl_add_u32 v99, v98, 1, v97
    v_lshl_add_u32 v97, v10, 3, v99
    v_lshrrev_b32 v98, 3, v2
    v_lshl_add_u32 v97, v98, 2, v97
    v_lshlrev_b32 v97, 1, v97
    s_lshl_b32 s12, s3, 7
    v_add_u32 v97, s12, v97
    s_mov_b32 s14, 1600000
L_lw1:
    s_sleep 4
    ds_read_b32 v80, v121 offset:6672
    s_sub_u32 s14, s14, 1
    s_cbranch_scc1 L_lx1
    s_waitcnt lgkmcnt(0)
    v_cmp_gt_u32 vcc, 4, v80
    s_cbranch_vccnz L_lw1
L_lx1:
    s_mov_b32 s14, 200008
L_poll_q:
    buffer_load_dword v100, v101, s[52:55], s85 offen sc1
    buffer_load_dwordx4 v[20:23], v96, s[52:55], s10 offen sc1
    s_mov_b32 exec_hi, 0
    buffer_load_dwordx4 v[24:27], v96, s[52:55], s11 offen sc1
    s_mov_b32 exec_hi, -1
    s_waitcnt vmcnt(0)
    v_xor_b32 v20, s42, v20
    v_xor_b32 v21, s93, v21
    v_xor_b32 v22, s94, v22
    v_xor_b32 v23, s95, v23
    v_or3_b32 v28, v20, v21, v22
    v_or_b32 v28, v23, v28
    s_mov_b32 exec_hi, 0
    v_xor_b32 v24, s42, v24
    v_xor_b32 v25, s93, v25
    v_xor_b32 v26, s94, v26
    v_xor_b32 v27, s95, v27
    v_or3_b32 v28, v24, v25, v28
    v_or3_b32 v28, v26, v27, v28
    v_add_f32 v20, v20, v24
    v_add_f32 v21, v21, v25
    v_add_f32 v22, v22, v26
    v_add_f32 v23, v23, v27
    s_mov_b32 exec_hi, -1
    v_and_b32 v28, 0xff, v28
    v_cmp_ne_u32 vcc, 0, v28
    s_cbranch_vccz L_q_ok
    s_sleep 6
    s_sub_u32 s14, s14, 1
    s_cmp_lg_u32 s14, 200000
    s_cbranch_scc1 L_q_more
    s_mov_b64 exec, 0x00ff00ff
    buffer_store_dwordx4 v[116:119], v120, s[52:55], s15 offen sc1
    s_mov_b64 exec, -1
L_q_more:
    s_cmp_gt_u32 s14, 200000
    s_cselect_b32 s86, 0, 2097152
    s_xor_b32 s10, s10, s86
    s_xor_b32 s11, s11, s86
    s_cmp_lg_u32 s14, 0
    s_cbranch_scc1 L_poll_q
L_q_ok:
    v_permlane32_swap_b32 v20, v21
    v_permlane32_swap_b32 v22, v23
    v_add_f32 v20, v20, v21
    v_add_f32 v22, v22, v23
    s_nop 1
    v_permlane16_swap_b32 v20, v22
    v_add_f32 v20, v20, v22
    v_cvt_pk_bf16_f32 v20, v20, v20
    ds_write_b16 v97, v20 offset:0
    s_mov_b64 exec, 1
    ds_add_u32 v121, v122 offset:6660
    s_mov_b64 exec, -1
    v_cmp_ne_u32 vcc, s84, v100
    s_cmp_lg_u64 vcc, 0
    s_cselect_b32 s87, 1, 0
    s_cbranch_scc0 L_local1
    s_mov_b64 exec, 0x00ff00ff
    buffer_store_dwordx4 v[116:119], v120, s[52:55], s15 offen sc1
    s_mov_b64 exec, -1
L_local1:
    s_cmp_eq_u32 s3, 1
    s_cbranch_scc1 L_wave1
    s_cmp_gt_u32 s3, 1
    s_cbranch_scc1 L_reduce
    s_add_u32 s9, s8, 2097152
    v_lshrrev_b32 v11, 5, v0
    v_lshlrev_b32 v12, 6, v11
    v_lshlrev_b32 v11, 9, v11
    v_and_b32 v13, 3, v0
    v_lshl_add_u32 v12, v13, 4, v12
    s_mov_b32 s14, 1600000
L_lw2:
    s_sleep 4
    ds_read_b32 v80, v121 offset:6664
    s_sub_u32 s14, s14, 1
    s_cbranch_scc1 L_lx2
    s_waitcnt lgkmcnt(0)
    v_cmp_gt_u32 vcc, 4, v80
    s_cbranch_vccnz L_lw2
L_lx2:
    ds_read2_b32 v[52:53], v11 offset0:128 offset1:132
    ds_read2_b32 v[54:55], v11 offset0:136 offset1:140
    ds_read_b128 v[36:39], v11 offset:1536
    ds_read_b128 v[40:43], v11 offset:1552
    ds_read_b128 v[44:47], v11 offset:1568
    ds_read_b128 v[48:51], v11 offset:1584
    s_waitcnt lgkmcnt(4)
    v_max3_f32 v56, v52, v53, v54
    v_max_f32 v56, v56, v55
    v_and_b32 v56, v56, v19
    v_sub_f32 v52, v52, v56
    v_sub_f32 v53, v53, v56
    v_sub_f32 v54, v54, v56
    v_sub_f32 v55, v55, v56
    v_exp_f32 v52, v52
    v_exp_f32 v53, v53
    v_exp_f32 v54, v54
    v_exp_f32 v55, v55
    s_waitcnt lgkmcnt(0)
    v_add_f32 v36, v36, v37
    v_add_f32 v40, v40, v41
    v_add_f32 v44, v44, v45
    v_add_f32 v48, v48, v49
    v_add_f32 v38, v38, v39
    v_add_f32 v42, v42, v43
    v_add_f32 v46, v46, v47
    v_add_f32 v50, v50, v51
    v_add_f32 v36, v36, v38
    v_add_f32 v40, v40, v42
    v_add_f32 v44, v44, v46
    v_add_f32 v48, v48, v50
    v_mul_f32 v57, v52, v36
    v_fmac_f32 v57, v53, v40
    v_fmac_f32 v57, v54, v44
    v_fmac_f32 v57, v55, v48
    v_or_b32 v58, s94, v56
    v_or_b32 v56, s42, v56
    v_and_or_b32 v59, v57, v19, s95
    v_and_or_b32 v57, v57, v19, s93
    s_mov_b32 exec_lo, 15
    s_mov_b32 exec_hi, 15
    buffer_store_dwordx4 v[56:59], v12, s[52:55], s8 offen offset:1024
    s_cmp_eq_u32 s87, 0
    s_cbranch_scc1 L_local2
    buffer_store_dwordx4 v[56:59], v12, s[52:55], s9 offen offset:1024 sc1
L_local2:
    s_mov_b64 exec, -1
    s_mov_b32 s14, 1600000
L_lw3:
    s_sleep 4
    ds_read_b32 v80, v121 offset:6668
    s_sub_u32 s14, s14, 1
    s_cbranch_scc1 L_lx3
    s_waitcnt lgkmcnt(0)
    v_cmp_gt_u32 vcc, 4, v80
    s_cbranch_vccnz L_lw3
L_lx3:
    s_mov_b32 s14, 1600000
L_mrg:
    s_waitcnt lgkmcnt(0)
    ds_read_b32 v80, v121 offset:6656
    ds_read_b128 v[20:23], v3 offset:2560
    ds_read_b128 v[24:27], v3 offset:3584
    ds_read_b128 v[28:31], v3 offset:4608
    ds_read_b128 v[32:35], v3 offset:5632
    s_sub_u32 s14, s14, 1
    s_cbranch_scc1 L_mrx
    s_waitcnt lgkmcnt(4)
    v_cmp_gt_u32 vcc, 4, v80
    s_cbranch_vccnz L_mrg
L_mrx:
    s_waitcnt lgkmcnt(0)
    s_mov_b64 exec, 1
    ds_add_u32 v121, v122 offset:6676
    s_mov_b64 exec, -1
    v_mul_f32 v20, v52, v20
    v_mul_f32 v21, v52, v21
    v_mul_f32 v22, v52, v22
    v_mul_f32 v23, v52, v23
    v_fmac_f32 v20, v53, v24
    v_fmac_f32 v21, v53, v25
    v_fmac_f32 v22, v53, v26
    v_fmac_f32 v23, v53, v27
    v_fmac_f32 v20, v54, v28
    v_fmac_f32 v21, v54, v29
    v_fmac_f32 v22, v54, v30
    v_fmac_f32 v23, v54, v31
    v_fmac_f32 v20, v55, v32
    v_fmac_f32 v21, v55, v33
    v_fmac_f32 v22, v55, v34
    v_fmac_f32 v23, v55, v35
    v_and_or_b32 v20, v20, v19, s42
    v_and_or_b32 v21, v21, v19, s93
    v_and_or_b32 v22, v22, v19, s94
    v_and_or_b32 v23, v23, v19, s95
    buffer_store_dwordx4 v[20:23], v3, s[52:55], s8 offen
    s_cmp_eq_u32 s87, 0
    s_cbranch_scc1 L_local3
    buffer_store_dwordx4 v[20:23], v3, s[52:55], s9 offen sc1
L_local3:
    s_endpgm
L_reduce:
    s_and_b32 s59, s2, 7
    s_lshr_b32 s12, s2, 7
    s_lshl3_add_u32 s11, s12, s59
    s_lshl4_add_u32 s11, s11, s5
    s_lshl3_add_u32 s12, s12, s5
    s_lshl4_add_u32 s59, s59, s12
    s_add_u32 s59, s59, 256
    s_cmp_ge_u32 s5, 8
    s_cselect_b32 s59, 288, s59
    s_cmp_eq_u32 s3, 2
    s_cselect_b32 s59, s11, s59
    s_cmp_ge_u32 s59, 288
    s_cbranch_scc1 L_hdone
    s_cmp_ge_u32 s59, 144
    s_cselect_b32 s11, 144, 0
    s_cselect_b32 s12, 34816, 0
    s_sub_u32 s11, s59, s11
    s_lshl4_add_u32 s11, s11, s12
    s_add_u32 s11, s11, 271616
    v_lshrrev_b32 v116, 2, v0
    v_lshlrev_b32 v116, 3, v116
    v_and_b32 v118, 3, v0
    v_add_u32 v116, v116, v118
    v_mul_u32_u24 v116, 8704, v116
    v_lshlrev_b32 v117, 1, v99
    s_andn2_b32 s88, s59, 15
    s_lshl_b32 s88, s88, 3
    s_and_b32 s89, s59, 7
    s_lshl4_add_u32 s88, s89, s88
    s_and_b32 s89, s59, 8
    s_add_u32 s88, s88, s89
    s_mov_b32 s60, s36
    s_mov_b32 s61, s37
    s_movk_i32 s62, 2304
    s_mov_b32 s63, 0x20000
    s_mov_b32 s14, 200000
    s_mov_b64 s[80:81], -1
    s_mov_b64 s[82:83], -1
    s_barrier
L_poll_y:
    s_mov_b64 exec, s[80:81]
    buffer_load_dwordx4 v[20:23], v116, s[52:55], s11 offen sc1
    s_waitcnt vmcnt(0)
    v_xor_b32 v40, s42, v20
    v_xor_b32 v41, s93, v21
    v_xor_b32 v42, s94, v22
    v_xor_b32 v43, s95, v23
    v_or3_b32 v28, v40, v41, v42
    v_or_b32 v28, v43, v28
    v_and_b32 v28, 0xff, v28
    v_cmp_ne_u32 s[80:81], 0, v28
    s_cmp_eq_u64 s[80:81], 0
    s_cbranch_scc1 L_y_ok
    s_sub_u32 s14, s14, 1
    s_cmp_lg_u32 s14, 0
    s_cbranch_scc1 L_poll_y
L_y_ok:
    s_mov_b64 exec, -1
    v_permlane32_swap_b32 v40, v41
    v_permlane32_swap_b32 v42, v43
    v_add_f32 v40, v40, v41
    v_add_f32 v42, v42, v43
    s_nop 1
    v_permlane16_swap_b32 v40, v42
    v_add_f32 v40, v40, v42
    s_nop 1
    v_add_f32_dpp v40, v40, v40 row_ror:8 row_mask:0xf bank_mask:0xf
    s_nop 1
    v_add_f32_dpp v40, v40, v40 row_ror:4 row_mask:0xf bank_mask:0xf
    s_nop 1
    v_add_f32_dpp v40, v40, v40 row_ror:2 row_mask:0xf bank_mask:0xf
    s_nop 1
    v_add_f32_dpp v40, v40, v40 row_ror:1 row_mask:0xf bank_mask:0xf
    v_cvt_pk_bf16_f32 v40, v40, v40
    s_mov_b32 exec_lo, 0x00010001
    s_mov_b32 exec_hi, 0x00010001
    buffer_store_short v40, v117, s[60:63], s88 offen
    s_cmp_eq_u32 s2, 0
    s_cbranch_scc0 L_hdone
    s_barrier
    s_mov_b64 exec, 0xff
    v_mov_b32 v44, s43
    v_mov_b32 v45, s43
    v_mov_b32 v46, s43
    v_mov_b32 v47, s43
    buffer_store_dwordx4 v[44:47], v3, s[52:55], 0 offen
L_hdone:
    s_endpgm
L_wave1:
    s_cmp_gt_u32 s5, 7
    s_cbranch_scc1 L_end
    s_lshl_b32 s12, s5, 1
    s_and_b32 s86, s12, 6
    s_cmp_ge_u32 s12, 8
    s_cselect_b64 s[60:61], s[34:35], s[24:25]
    s_cselect_b32 s87, 0, 13
    s_cselect_b32 s88, 13, 3
    s_mov_b32 s62, 0x480000
    s_mov_b32 s63, 0x20000
    s_lshl3_add_u32 s59, s4, s86
    s_mul_i32 s59, s59, 36864
    s_lshl_b32 s89, 8, 7
    s_add_u32 s59, s59, s89
    s_add_u32 s92, s59, 36864
    s_andn2_b32 s58, s12, 1
    s_lshl4_add_u32 s58, s4, s58
    s_mul_i32 s58, s58, 4352
    s_lshl1_add_u32 s58, s89, s58
    s_add_u32 s58, s58, 270336
    s_lshl4_add_u32 s87, s4, s87
    s_mul_i32 s87, s87, 4352
    s_add_u32 s87, s87, 270336
    s_lshr_b32 s56, s86, 2
    s_lshl_b32 s56, s56, 6
    s_add_u32 s56, s56, s87
    s_lshl_b32 s57, s86, 7
    s_add_u32 s57, s57, s87
    v_lshrrev_b32 v216, 3, v0
    v_and_b32 v217, 7, v0
    v_mul_u32_u24 v224, 4608, v216
    v_lshl_add_u32 v224, v217, 4, v224
    v_cmp_gt_u32 s[80:81], s88, v217
    v_add_u32 v226, 8, v217
    v_cmp_gt_u32 s[82:83], s88, v226
    v_cndmask_b32 v225, 0, v217, s[80:81]
    s_nop 0
    v_cndmask_b32 v226, 0, v226, s[82:83]
    v_mul_u32_u24 v225, 4352, v225
    v_mul_u32_u24 v226, 4352, v226
    v_lshl_add_u32 v229, v216, 4, v225
    v_lshl_add_u32 v230, v216, 4, v226
    v_mov_b32 v227, 0xffffff00
    v_lshlrev_b32 v228, 4, v2
    v_lshl_add_u32 v228, v1, 7, v228
    buffer_load_dwordx4 v[184:187], v224, s[60:63], s59 offen offset:0 nt
    buffer_load_dwordx4 v[188:191], v224, s[60:63], s59 offen offset:1152 nt
    buffer_load_dwordx4 v[192:195], v224, s[60:63], s59 offen offset:2304 nt
    buffer_load_dwordx4 v[196:199], v224, s[60:63], s59 offen offset:3456 nt
    s_mov_b32 s14, 1600000
L_lw4:
    s_sleep 4
    ds_read_b32 v80, v121 offset:6668
    s_sub_u32 s14, s14, 1
    s_cbranch_scc1 L_lx4
    s_waitcnt lgkmcnt(0)
    v_cmp_gt_u32 vcc, 4, v80
    s_cbranch_vccnz L_lw4
L_lx4:
    buffer_load_dwordx4 v[216:219], v225, s[52:55], s56 offen offset:1024 sc1
    buffer_load_dwordx4 v[220:223], v226, s[52:55], s56 offen offset:1024 sc1
    s_mov_b32 s14, 1600000
L_lw5:
    s_sleep 1
    ds_read_b32 v80, v121 offset:6656
    s_sub_u32 s14, s14, 1
    s_cbranch_scc1 L_lx5
    s_waitcnt lgkmcnt(0)
    v_cmp_gt_u32 vcc, 3, v80
    s_cbranch_vccnz L_lw5
L_lx5:
    s_waitcnt vmcnt(0)
    s_branch L_st_chk0
L_stream2:
    s_add_u32 s48, s48, s14
    s_addc_u32 s49, s49, 0
    s_mov_b32 s50, s46
    s_mov_b32 s51, 0x20000
    v_bfe_u32 v11, v0, 3, 1
    v_lshlrev_b32 v11, 8, v11
    v_lshl_add_u32 v11, v1, 6, v11
    v_lshl_add_u32 v11, v10, 4, v11
    s_load_dword s42, s[40:41], 0
    v_and_b32 v0, 63, v0
    v_lshrrev_b32 v1, 4, v0
    v_and_b32 v2, 15, v0
    v_lshlrev_b32 v3, 4, v0
    s_lshl4_add_u32 s6, s4, s5
    s_mul_i32 s8, s6, 4352
    s_add_u32 s8, s8, 270336
    s_mov_b32 s52, s40
    s_mov_b32 s53, s41
    s_mov_b32 s54, 16777216
    s_mov_b32 s55, 0x20000
    v_and_b32 v8, 1, v0
    v_lshlrev_b32 v8, 4, v8
    v_mov_b32 v7, 0xffff
    v_lshlrev_b32 v8, v8, v7
    v_bfe_u32 v7, v0, 1, 2
    v_cmp_eq_u32 vcc, 0, v7
    s_nop 1
    v_cndmask_b32 v4, 0, v8, vcc
    v_cmp_eq_u32 vcc, 1, v7
    s_nop 1
    v_cndmask_b32 v5, 0, v8, vcc
    v_cmp_eq_u32 vcc, 2, v7
    s_nop 1
    v_cndmask_b32 v6, 0, v8, vcc
    v_cmp_eq_u32 vcc, 3, v7
    s_nop 1
    v_cndmask_b32 v7, 0, v8, vcc
    v_lshrrev_b32 v8, 1, v1
    v_lshlrev_b32 v8, 9, v8
    v_lshl_add_u32 v8, v2, 5, v8
    v_and_b32 v254, 1, v1
    v_lshl_add_u32 v8, v254, 4, v8
    s_lshl_b32 s12, s9, 10
    v_add_u32 v8, s12, v8
    s_barrier
    s_cmp_gt_u32 s15, 3
    s_cselect_b32 s84, 0, 0xff800000
    s_cmp_gt_u32 s15, 4
    s_cselect_b32 s85, 0, 0xff800000
    s_cmp_gt_u32 s15, 5
    s_cselect_b32 s86, 0, 0xff800000
    s_cmp_gt_u32 s15, 6
    s_cselect_b32 s87, 0, 0xff800000
    s_waitcnt vmcnt(7)
    buffer_load_dwordx4 v[44:47], v9, s[44:47], 0 offen offset:0 nt
    s_waitcnt vmcnt(7)
    buffer_load_dwordx4 v[48:51], v9, s[44:47], 0 offen offset:1024 nt
    s_waitcnt vmcnt(7)
    buffer_load_dwordx4 v[52:55], v9, s[44:47], 0 offen offset:2048 nt
    s_waitcnt vmcnt(7)
    buffer_load_dwordx4 v[56:59], v9, s[44:47], 0 offen offset:3072 nt
    v_add_u32 v9, s13, v9
    s_waitcnt vmcnt(7)
    buffer_load_dwordx4 v[60:63], v9, s[44:47], 0 offen offset:0 nt
    s_waitcnt vmcnt(7)
    buffer_load_dwordx4 v[64:67], v9, s[44:47], 0 offen offset:1024 nt
    s_waitcnt vmcnt(7)
    buffer_load_dwordx4 v[68:71], v9, s[44:47], 0 offen offset:2048 nt
    s_waitcnt vmcnt(7)
    buffer_load_dwordx4 v[72:75], v9, s[44:47], 0 offen offset:3072 nt
    v_add_u32 v9, s13, v9
    s_waitcnt vmcnt(7)
    buffer_load_dwordx4 v[76:79], v9, s[44:47], 0 offen offset:0 nt
    s_waitcnt vmcnt(7)
    buffer_load_dwordx4 v[80:83], v9, s[44:47], 0 offen offset:1024 nt
    s_waitcnt vmcnt(7)
    buffer_load_dwordx4 v[84:87], v9, s[44:47], 0 offen offset:2048 nt
    s_waitcnt vmcnt(7)
    buffer_load_dwordx4 v[88:91], v9, s[44:47], 0 offen offset:3072 nt
    v_add_u32 v9, s13, v9
    s_waitcnt vmcnt(7)
    buffer_load_dwordx4 v[92:95], v9, s[44:47], 0 offen offset:0 nt
    s_waitcnt vmcnt(7)
    buffer_load_dwordx4 v[96:99], v9, s[44:47], 0 offen offset:1024 nt
    s_waitcnt vmcnt(7)
    buffer_load_dwordx4 v[100:103], v9, s[44:47], 0 offen offset:2048 nt
    s_waitcnt vmcnt(7)
    buffer_load_dwordx4 v[104:107], v9, s[44:47], 0 offen offset:3072 nt
    v_add_u32 v9, s13, v9
    s_waitcnt vmcnt(7)
    buffer_load_dwordx4 v[108:111], v9, s[44:47], 0 offen offset:0 nt
    s_waitcnt vmcnt(7)
    buffer_load_dwordx4 v[112:115], v9, s[44:47], 0 offen offset:1024 nt
    s_waitcnt vmcnt(7)
    buffer_load_dwordx4 v[116:119], v9, s[44:47], 0 offen offset:2048 nt
    s_waitcnt vmcnt(7)
    buffer_load_dwordx4 v[120:123], v9, s[44:47], 0 offen offset:3072 nt
    v_add_u32 v9, s13, v9
    s_waitcnt vmcnt(7)
    buffer_load_dwordx4 v[124:127], v9, s[44:47], 0 offen offset:0 nt
    s_waitcnt vmcnt(7)
    buffer_load_dwordx4 v[128:131], v9, s[44:47], 0 offen offset:1024 nt
    s_waitcnt vmcnt(7)
    buffer_load_dwordx4 v[132:135], v9, s[44:47], 0 offen offset:2048 nt
    s_waitcnt vmcnt(7)
    buffer_load_dwordx4 v[136:139], v9, s[44:47], 0 offen offset:3072 nt
    v_add_u32 v9, s13, v9
    s_waitcnt vmcnt(7)
    buffer_load_dwordx4 v[140:143], v9, s[44:47], 0 offen offset:0 nt
    s_waitcnt vmcnt(7)
    buffer_load_dwordx4 v[144:147], v9, s[44:47], 0 offen offset:1024 nt
    s_waitcnt vmcnt(7)
    buffer_load_dwordx4 v[148:151], v9, s[44:47], 0 offen offset:2048 nt
    v_mov_b32 v253, 1
    v_mov_b32 v254, 0
    s_mov_b64 exec, 1
    ds_add_u32 v254, v253 offset:6672
    s_mov_b64 exec, -1
    s_waitcnt vmcnt(7)
    buffer_load_dwordx4 v[152:155], v9, s[44:47], 0 offen offset:3072 nt
    s_waitcnt vmcnt(7)
    v_add_u32 v9, s11, v255
    buffer_load_dwordx4 v[156:159], v9, s[44:47], 0 offen offset:0 nt
    s_waitcnt vmcnt(7)
    buffer_load_dwordx4 v[160:163], v9, s[44:47], 0 offen offset:1024 nt
    s_waitcnt vmcnt(7)
    buffer_load_dwordx4 v[164:167], v9, s[44:47], 0 offen offset:2048 nt
    s_waitcnt vmcnt(7)
    buffer_load_dwordx4 v[168:171], v9, s[44:47], 0 offen offset:3072 nt
    s_waitcnt vmcnt(8)
    v_add_u32 v9, 0x1000, v9
    buffer_load_dwordx4 v[172:175], v9, s[44:47], 0 offen offset:0 nt
    s_waitcnt vmcnt(9)
    buffer_load_dwordx4 v[176:179], v9, s[44:47], 0 offen offset:1024 nt
    s_waitcnt vmcnt(10)
    buffer_load_dwordx4 v[180:183], v9, s[44:47], 0 offen offset:2048 nt
    s_waitcnt vmcnt(11)
    v_add_u32 v10, s10, v3
    buffer_load_dwordx4 v[184:187], v10, s[48:51], 0 offen offset:0 nt
    s_waitcnt vmcnt(11)
    buffer_load_dwordx4 v[188:191], v10, s[48:51], 0 offen offset:1024 nt
    s_waitcnt vmcnt(11)
    buffer_load_dwordx4 v[192:195], v10, s[48:51], 0 offen offset:2048 nt
    s_waitcnt vmcnt(11)
    buffer_load_dwordx4 v[196:199], v10, s[48:51], 0 offen offset:3072 nt
    v_add_u32 v10, s13, v10
    s_waitcnt vmcnt(11)
    buffer_load_dwordx4 v[200:203], v10, s[48:51], 0 offen offset:0 nt
    s_waitcnt vmcnt(11)
    buffer_load_dwordx4 v[204:207], v10, s[48:51], 0 offen offset:1024 nt
    s_waitcnt vmcnt(11)
    buffer_load_dwordx4 v[208:211], v10, s[48:51], 0 offen offset:2048 nt
    s_waitcnt vmcnt(11)
    buffer_load_dwordx4 v[212:215], v10, s[48:51], 0 offen offset:3072 nt
    v_add_u32 v10, s13, v10
    s_waitcnt vmcnt(7)
    buffer_load_dwordx4 v[216:219], v10, s[48:51], 0 offen offset:0 nt
    s_waitcnt vmcnt(7)
    buffer_load_dwordx4 v[220:223], v10, s[48:51], 0 offen offset:1024 nt
    s_waitcnt vmcnt(7)
    buffer_load_dwordx4 v[224:227], v10, s[48:51], 0 offen offset:2048 nt
    s_waitcnt vmcnt(7)
    buffer_load_dwordx4 v[228:231], v10, s[48:51], 0 offen offset:3072 nt
    v_add_u32 v10, s13, v10
    s_waitcnt lgkmcnt(0)
    s_add_u32 s43, s42, 1
    s_and_b32 s42, s43, 0xff
    s_lshr_b32 s93, s43, 8
    s_lshr_b32 s94, s43, 16
    s_lshr_b32 s95, s43, 24
    s_add_u32 s93, s93, s42
    s_add_u32 s94, s94, s42
    s_add_u32 s95, s95, s42
    s_and_b32 s93, s93, 0xff
    s_and_b32 s94, s94, 0xff
    s_and_b32 s95, s95, 0xff
    v_mov_b32 v254, 0
    s_mov_b32 s14, 1600000
L_lw6:
    ds_read_b32 v255, v254 offset:6660
    s_sub_u32 s14, s14, 1
    s_cbranch_scc1 L_lx6
    s_waitcnt lgkmcnt(0)
    v_cmp_gt_u32 vcc, 4, v255
    s_cbranch_vccnz L_lw6
L_lx6:
    ds_read_b128 v[232:235], v11 offset:0
    s_waitcnt lgkmcnt(0)
    v_mfma_f32_16x16x32_bf16 v[236:239], v[12:15], v[232:235], 0
    v_mfma_f32_16x16x32_bf16 v[240:243], v[16:19], v[232:235], 0
    v_add_u32 v10, s11, v3
    buffer_load_dwordx4 v[16:19], v10, s[48:51], 0 offen offset:0 nt
    v_mfma_f32_16x16x32_bf16 v[244:247], v[20:23], v[232:235], 0
    s_nop 3
    v_mov_b32_dpp v12, v236 quad_perm:[0,0,0,0] row_mask:0xf bank_mask:0xf
    v_mfma_f32_16x16x32_bf16 v[248:251], v[24:27], v[232:235], 0
    v_mov_b32_dpp v13, v240 quad_perm:[0,0,0,0] row_mask:0xf bank_mask:0xf
    v_add_f32_dpp v12, v237, v12 quad_perm:[1,1,1,1] row_mask:0xf bank_mask:0xf
    v_mfma_f32_16x16x32_bf16 v[252:255], v[28:31], v[232:235], 0
    s_nop 0
    v_add_f32_dpp v12, v238, v12 quad_perm:[2,2,2,2] row_mask:0xf bank_mask:0xf
    v_mov_b32_dpp v14, v244 quad_perm:[0,0,0,0] row_mask:0xf bank_mask:0xf
    v_add_f32_dpp v13, v241, v13 quad_perm:[1,1,1,1] row_mask:0xf bank_mask:0xf
    v_add_f32_dpp v12, v239, v12 quad_perm:[3,3,3,3] row_mask:0xf bank_mask:0xf
    v_mfma_f32_16x16x32_bf16 v[236:239], v[32:35], v[232:235], 0
    v_add_f32_dpp v13, v242, v13 quad_perm:[2,2,2,2] row_mask:0xf bank_mask:0xf
    v_mov_b32_dpp v15, v248 quad_perm:[0,0,0,0] row_mask:0xf bank_mask:0xf
    v_add_f32_dpp v14, v245, v14 quad_perm:[1,1,1,1] row_mask:0xf bank_mask:0xf
    v_add_f32_dpp v13, v243, v13 quad_perm:[3,3,3,3] row_mask:0xf bank_mask:0xf
    v_mfma_f32_16x16x32_bf16 v[240:243], v[36:39], v[232:235], 0
    v_add_f32_dpp v14, v246, v14 quad_perm:[2,2,2,2] row_mask:0xf bank_mask:0xf
    v_mov_b32_dpp v28, v252 quad_perm:[0,0,0,0] row_mask:0xf bank_mask:0xf
    v_add_f32_dpp v15, v249, v15 quad_perm:[1,1,1,1] row_mask:0xf bank_mask:0xf
    v_add_f32_dpp v14, v247, v14 quad_perm:[3,3,3,3] row_mask:0xf bank_mask:0xf
    v_mfma_f32_16x16x32_bf16 v[244:247], v[40:43], v[232:235], 0
    v_add_f32_dpp v15, v250, v15 quad_perm:[2,2,2,2] row_mask:0xf bank_mask:0xf
    v_mov_b32_dpp v29, v236 quad_perm:[0,0,0,0] row_mask:0xf bank_mask:0xf
    v_add_f32_dpp v28, v253, v28 quad_perm:[1,1,1,1] row_mask:0xf bank_mask:0xf
    v_add_f32_dpp v15, v251, v15 quad_perm:[3,3,3,3] row_mask:0xf bank_mask:0xf
    v_mfma_f32_16x16x32_bf16 v[248:251], v[44:47], v[232:235], 0
    buffer_load_dwordx4 v[20:23], v10, s[48:51], 0 offen offset:1024 nt
    v_add_f32_dpp v28, v254, v28 quad_perm:[2,2,2,2] row_mask:0xf bank_mask:0xf
    v_mov_b32_dpp v30, v240 quad_perm:[0,0,0,0] row_mask:0xf bank_mask:0xf
    v_add_f32_dpp v29, v237, v29 quad_perm:[1,1,1,1] row_mask:0xf bank_mask:0xf
    v_add_f32_dpp v28, v255, v28 quad_perm:[3,3,3,3] row_mask:0xf bank_mask:0xf
    v_mfma_f32_16x16x32_bf16 v[252:255], v[48:51], v[232:235], 0
    v_add_f32_dpp v29, v238, v29 quad_perm:[2,2,2,2] row_mask:0xf bank_mask:0xf
    v_mov_b32_dpp v31, v244 quad_perm:[0,0,0,0] row_mask:0xf bank_mask:0xf
    v_add_f32_dpp v30, v241, v30 quad_perm:[1,1,1,1] row_mask:0xf bank_mask:0xf
    v_add_f32_dpp v29, v239, v29 quad_perm:[3,3,3,3] row_mask:0xf bank_mask:0xf
    v_mfma_f32_16x16x32_bf16 v[236:239], v[52:55], v[232:235], 0
    v_add_f32_dpp v30, v242, v30 quad_perm:[2,2,2,2] row_mask:0xf bank_mask:0xf
    v_mov_b32_dpp v44, v248 quad_perm:[0,0,0,0] row_mask:0xf bank_mask:0xf
    v_add_f32_dpp v31, v245, v31 quad_perm:[1,1,1,1] row_mask:0xf bank_mask:0xf
    v_add_f32_dpp v30, v243, v30 quad_perm:[3,3,3,3] row_mask:0xf bank_mask:0xf
    v_mfma_f32_16x16x32_bf16 v[240:243], v[56:59], v[232:235], 0
    v_add_f32_dpp v31, v246, v31 quad_perm:[2,2,2,2] row_mask:0xf bank_mask:0xf
    v_mov_b32_dpp v45, v252 quad_perm:[0,0,0,0] row_mask:0xf bank_mask:0xf
    v_add_f32_dpp v44, v249, v44 quad_perm:[1,1,1,1] row_mask:0xf bank_mask:0xf
    v_add_f32_dpp v31, v247, v31 quad_perm:[3,3,3,3] row_mask:0xf bank_mask:0xf
    v_mfma_f32_16x16x32_bf16 v[244:247], v[60:63], v[232:235], 0
    v_add_f32_dpp v44, v250, v44 quad_perm:[2,2,2,2] row_mask:0xf bank_mask:0xf
    v_mov_b32_dpp v46, v236 quad_perm:[0,0,0,0] row_mask:0xf bank_mask:0xf
    v_add_f32_dpp v45, v253, v45 quad_perm:[1,1,1,1] row_mask:0xf bank_mask:0xf
    v_add_f32_dpp v44, v251, v44 quad_perm:[3,3,3,3] row_mask:0xf bank_mask:0xf
    v_mfma_f32_16x16x32_bf16 v[248:251], v[64:67], v[232:235], 0
    v_add_f32_dpp v45, v254, v45 quad_perm:[2,2,2,2] row_mask:0xf bank_mask:0xf
    v_mov_b32_dpp v47, v240 quad_perm:[0,0,0,0] row_mask:0xf bank_mask:0xf
    v_add_f32_dpp v46, v237, v46 quad_perm:[1,1,1,1] row_mask:0xf bank_mask:0xf
    v_add_f32_dpp v45, v255, v45 quad_perm:[3,3,3,3] row_mask:0xf bank_mask:0xf
    v_mfma_f32_16x16x32_bf16 v[252:255], v[68:71], v[232:235], 0
    v_add_f32_dpp v46, v238, v46 quad_perm:[2,2,2,2] row_mask:0xf bank_mask:0xf
    v_mov_b32_dpp v60, v244 quad_perm:[0,0,0,0] row_mask:0xf bank_mask:0xf
    v_add_f32_dpp v47, v241, v47 quad_perm:[1,1,1,1] row_mask:0xf bank_mask:0xf
    v_add_f32_dpp v46, v239, v46 quad_perm:[3,3,3,3] row_mask:0xf bank_mask:0xf
    v_mfma_f32_16x16x32_bf16 v[236:239], v[72:75], v[232:235], 0
    buffer_load_dwordx4 v[24:27], v10, s[48:51], 0 offen offset:2048 nt
    v_add_f32_dpp v47, v242, v47 quad_perm:[2,2,2,2] row_mask:0xf bank_mask:0xf
    v_mov_b32_dpp v61, v248 quad_perm:[0,0,0,0] row_mask:0xf bank_mask:0xf
    v_add_f32_dpp v60, v245, v60 quad_perm:[1,1,1,1] row_mask:0xf bank_mask:0xf
    v_add_f32_dpp v47, v243, v47 quad_perm:[3,3,3,3] row_mask:0xf bank_mask:0xf
    v_mfma_f32_16x16x32_bf16 v[240:243], v[76:79], v[232:235], 0
    v_add_f32_dpp v60, v246, v60 quad_perm:[2,2,2,2] row_mask:0xf bank_mask:0xf
    v_mov_b32_dpp v62, v252 quad_perm:[0,0,0,0] row_mask:0xf bank_mask:0xf
    v_add_f32_dpp v61, v249, v61 quad_perm:[1,1,1,1] row_mask:0xf bank_mask:0xf
    v_add_f32_dpp v60, v247, v60 quad_perm:[3,3,3,3] row_mask:0xf bank_mask:0xf
    v_mfma_f32_16x16x32_bf16 v[244:247], v[80:83], v[232:235], 0
    v_add_f32_dpp v61, v250, v61 quad_perm:[2,2,2,2] row_mask:0xf bank_mask:0xf
    v_mov_b32_dpp v63, v236 quad_perm:[0,0,0,0] row_mask:0xf bank_mask:0xf
    v_add_f32_dpp v62, v253, v62 quad_perm:[1,1,1,1] row_mask:0xf bank_mask:0xf
    v_add_f32_dpp v61, v251, v61 quad_perm:[3,3,3,3] row_mask:0xf bank_mask:0xf
    v_mfma_f32_16x16x32_bf16 v[248:251], v[84:87], v[232:235], 0
    v_add_f32_dpp v62, v254, v62 quad_perm:[2,2,2,2] row_mask:0xf bank_mask:0xf
    v_mov_b32_dpp v76, v240 quad_perm:[0,0,0,0] row_mask:0xf bank_mask:0xf
    v_add_f32_dpp v63, v237, v63 quad_perm:[1,1,1,1] row_mask:0xf bank_mask:0xf
    v_add_f32_dpp v62, v255, v62 quad_perm:[3,3,3,3] row_mask:0xf bank_mask:0xf
    v_mfma_f32_16x16x32_bf16 v[252:255], v[88:91], v[232:235], 0
    v_add_f32_dpp v63, v238, v63 quad_perm:[2,2,2,2] row_mask:0xf bank_mask:0xf
    v_mov_b32_dpp v77, v244 quad_perm:[0,0,0,0] row_mask:0xf bank_mask:0xf
    v_add_f32_dpp v76, v241, v76 quad_perm:[1,1,1,1] row_mask:0xf bank_mask:0xf
    v_add_f32_dpp v63, v239, v63 quad_perm:[3,3,3,3] row_mask:0xf bank_mask:0xf
    v_mfma_f32_16x16x32_bf16 v[236:239], v[92:95], v[232:235], 0
    v_add_f32_dpp v76, v242, v76 quad_perm:[2,2,2,2] row_mask:0xf bank_mask:0xf
    v_mov_b32_dpp v78, v248 quad_perm:[0,0,0,0] row_mask:0xf bank_mask:0xf
    v_add_f32_dpp v77, v245, v77 quad_perm:[1,1,1,1] row_mask:0xf bank_mask:0xf
    v_add_f32_dpp v76, v243, v76 quad_perm:[3,3,3,3] row_mask:0xf bank_mask:0xf
    v_mfma_f32_16x16x32_bf16 v[240:243], v[96:99], v[232:235], 0
    v_add_f32_dpp v77, v246, v77 quad_perm:[2,2,2,2] row_mask:0xf bank_mask:0xf
    v_mov_b32_dpp v79, v252 quad_perm:[0,0,0,0] row_mask:0xf bank_mask:0xf
    v_add_f32_dpp v78, v249, v78 quad_perm:[1,1,1,1] row_mask:0xf bank_mask:0xf
    v_add_f32_dpp v77, v247, v77 quad_perm:[3,3,3,3] row_mask:0xf bank_mask:0xf
    v_mfma_f32_16x16x32_bf16 v[244:247], v[100:103], v[232:235], 0
    buffer_load_dwordx4 v[32:35], v10, s[48:51], 0 offen offset:3072 nt
    v_add_u32 v10, 0x1000, v10
    buffer_load_dwordx4 v[36:39], v10, s[48:51], 0 offen offset:0 nt
    buffer_load_dwordx4 v[40:43], v10, s[48:51], 0 offen offset:1024 nt
    buffer_load_dwordx4 v[48:51], v10, s[48:51], 0 offen offset:2048 nt
    v_add_u32 v10, s10, v3
    v_add_u32 v10, 49152, v10
    buffer_load_dwordx4 v[52:55], v10, s[48:51], 0 offen offset:0 nt
    v_add_f32_dpp v78, v250, v78 quad_perm:[2,2,2,2] row_mask:0xf bank_mask:0xf
    v_mov_b32_dpp v92, v236 quad_perm:[0,0,0,0] row_mask:0xf bank_mask:0xf
    v_add_f32_dpp v79, v253, v79 quad_perm:[1,1,1,1] row_mask:0xf bank_mask:0xf
    v_add_f32_dpp v78, v251, v78 quad_perm:[3,3,3,3] row_mask:0xf bank_mask:0xf
    v_mfma_f32_16x16x32_bf16 v[248:251], v[104:107], v[232:235], 0
    v_add_f32_dpp v79, v254, v79 quad_perm:[2,2,2,2] row_mask:0xf bank_mask:0xf
    v_mov_b32_dpp v93, v240 quad_perm:[0,0,0,0] row_mask:0xf bank_mask:0xf
    v_add_f32_dpp v92, v237, v92 quad_perm:[1,1,1,1] row_mask:0xf bank_mask:0xf
    v_add_f32_dpp v79, v255, v79 quad_perm:[3,3,3,3] row_mask:0xf bank_mask:0xf
    v_mfma_f32_16x16x32_bf16 v[252:255], v[108:111], v[232:235], 0
    v_add_f32_dpp v92, v238, v92 quad_perm:[2,2,2,2] row_mask:0xf bank_mask:0xf
    v_mov_b32_dpp v94, v244 quad_perm:[0,0,0,0] row_mask:0xf bank_mask:0xf
    v_add_f32_dpp v93, v241, v93 quad_perm:[1,1,1,1] row_mask:0xf bank_mask:0xf
    v_add_f32_dpp v92, v239, v92 quad_perm:[3,3,3,3] row_mask:0xf bank_mask:0xf
    v_mfma_f32_16x16x32_bf16 v[236:239], v[112:115], v[232:235], 0
    v_add_f32_dpp v93, v242, v93 quad_perm:[2,2,2,2] row_mask:0xf bank_mask:0xf
    v_mov_b32_dpp v95, v248 quad_perm:[0,0,0,0] row_mask:0xf bank_mask:0xf
    v_add_f32_dpp v94, v245, v94 quad_perm:[1,1,1,1] row_mask:0xf bank_mask:0xf
    v_add_f32_dpp v93, v243, v93 quad_perm:[3,3,3,3] row_mask:0xf bank_mask:0xf
    v_mfma_f32_16x16x32_bf16 v[240:243], v[116:119], v[232:235], 0
    v_add_f32_dpp v94, v246, v94 quad_perm:[2,2,2,2] row_mask:0xf bank_mask:0xf
    v_mov_b32_dpp v108, v252 quad_perm:[0,0,0,0] row_mask:0xf bank_mask:0xf
    v_add_f32_dpp v95, v249, v95 quad_perm:[1,1,1,1] row_mask:0xf bank_mask:0xf
    v_add_f32_dpp v94, v247, v94 quad_perm:[3,3,3,3] row_mask:0xf bank_mask:0xf
    v_mfma_f32_16x16x32_bf16 v[244:247], v[120:123], v[232:235], 0
    v_add_f32_dpp v95, v250, v95 quad_perm:[2,2,2,2] row_mask:0xf bank_mask:0xf
    v_mov_b32_dpp v109, v236 quad_perm:[0,0,0,0] row_mask:0xf bank_mask:0xf
    v_add_f32_dpp v108, v253, v108 quad_perm:[1,1,1,1] row_mask:0xf bank_mask:0xf
    v_add_f32_dpp v95, v251, v95 quad_perm:[3,3,3,3] row_mask:0xf bank_mask:0xf
    v_mfma_f32_16x16x32_bf16 v[248:251], v[124:127], v[232:235], 0
    v_add_f32_dpp v108, v254, v108 quad_perm:[2,2,2,2] row_mask:0xf bank_mask:0xf
    v_mov_b32_dpp v110, v240 quad_perm:[0,0,0,0] row_mask:0xf bank_mask:0xf
    v_add_f32_dpp v109, v237, v109 quad_perm:[1,1,1,1] row_mask:0xf bank_mask:0xf
    v_add_f32_dpp v108, v255, v108 quad_perm:[3,3,3,3] row_mask:0xf bank_mask:0xf
    v_mfma_f32_16x16x32_bf16 v[252:255], v[128:131], v[232:235], 0
    buffer_load_dwordx4 v[56:59], v10, s[48:51], 0 offen offset:1024 nt
    v_add_f32_dpp v109, v238, v109 quad_perm:[2,2,2,2] row_mask:0xf bank_mask:0xf
    v_mov_b32_dpp v111, v244 quad_perm:[0,0,0,0] row_mask:0xf bank_mask:0xf
    v_add_f32_dpp v110, v241, v110 quad_perm:[1,1,1,1] row_mask:0xf bank_mask:0xf
    v_add_f32_dpp v109, v239, v109 quad_perm:[3,3,3,3] row_mask:0xf bank_mask:0xf
    v_mfma_f32_16x16x32_bf16 v[236:239], v[132:135], v[232:235], 0
    v_add_f32_dpp v110, v242, v110 quad_perm:[2,2,2,2] row_mask:0xf bank_mask:0xf
    v_mov_b32_dpp v124, v248 quad_perm:[0,0,0,0] row_mask:0xf bank_mask:0xf
    v_add_f32_dpp v111, v245, v111 quad_perm:[1,1,1,1] row_mask:0xf bank_mask:0xf
    v_add_f32_dpp v110, v243, v110 quad_perm:[3,3,3,3] row_mask:0xf bank_mask:0xf
    v_mfma_f32_16x16x32_bf16 v[240:243], v[136:139], v[232:235], 0
    v_add_f32_dpp v111, v246, v111 quad_perm:[2,2,2,2] row_mask:0xf bank_mask:0xf
    v_mov_b32_dpp v125, v252 quad_perm:[0,0,0,0] row_mask:0xf bank_mask:0xf
    v_add_f32_dpp v124, v249, v124 quad_perm:[1,1,1,1] row_mask:0xf bank_mask:0xf
    v_add_f32_dpp v111, v247, v111 quad_perm:[3,3,3,3] row_mask:0xf bank_mask:0xf
    v_mfma_f32_16x16x32_bf16 v[244:247], v[140:143], v[232:235], 0
    v_add_f32_dpp v124, v250, v124 quad_perm:[2,2,2,2] row_mask:0xf bank_mask:0xf
    v_mov_b32_dpp v126, v236 quad_perm:[0,0,0,0] row_mask:0xf bank_mask:0xf
    v_add_f32_dpp v125, v253, v125 quad_perm:[1,1,1,1] row_mask:0xf bank_mask:0xf
    v_add_f32_dpp v124, v251, v124 quad_perm:[3,3,3,3] row_mask:0xf bank_mask:0xf
    v_mfma_f32_16x16x32_bf16 v[248:251], v[144:147], v[232:235], 0
    v_add_f32_dpp v125, v254, v125 quad_perm:[2,2,2,2] row_mask:0xf bank_mask:0xf
    v_mov_b32_dpp v127, v240 quad_perm:[0,0,0,0] row_mask:0xf bank_mask:0xf
    v_add_f32_dpp v126, v237, v126 quad_perm:[1,1,1,1] row_mask:0xf bank_mask:0xf
    v_add_f32_dpp v125, v255, v125 quad_perm:[3,3,3,3] row_mask:0xf bank_mask:0xf
    v_mfma_f32_16x16x32_bf16 v[252:255], v[148:151], v[232:235], 0
    v_add_f32_dpp v126, v238, v126 quad_perm:[2,2,2,2] row_mask:0xf bank_mask:0xf
    v_mov_b32_dpp v140, v244 quad_perm:[0,0,0,0] row_mask:0xf bank_mask:0xf
    v_add_f32_dpp v127, v241, v127 quad_perm:[1,1,1,1] row_mask:0xf bank_mask:0xf
    v_add_f32_dpp v126, v239, v126 quad_perm:[3,3,3,3] row_mask:0xf bank_mask:0xf
    v_mfma_f32_16x16x32_bf16 v[236:239], v[152:155], v[232:235], 0
    v_add_f32_dpp v127, v242, v127 quad_perm:[2,2,2,2] row_mask:0xf bank_mask:0xf
    v_mov_b32_dpp v141, v248 quad_perm:[0,0,0,0] row_mask:0xf bank_mask:0xf
    v_add_f32_dpp v140, v245, v140 quad_perm:[1,1,1,1] row_mask:0xf bank_mask:0xf
    v_add_f32_dpp v127, v243, v127 quad_perm:[3,3,3,3] row_mask:0xf bank_mask:0xf
    v_mfma_f32_16x16x32_bf16 v[240:243], v[156:159], v[232:235], 0
    buffer_load_dwordx4 v[64:67], v10, s[48:51], 0 offen offset:2048 nt
    v_add_f32_dpp v140, v246, v140 quad_perm:[2,2,2,2] row_mask:0xf bank_mask:0xf
    v_mov_b32_dpp v142, v252 quad_perm:[0,0,0,0] row_mask:0xf bank_mask:0xf
    v_add_f32_dpp v141, v249, v141 quad_perm:[1,1,1,1] row_mask:0xf bank_mask:0xf
    v_add_f32_dpp v140, v247, v140 quad_perm:[3,3,3,3] row_mask:0xf bank_mask:0xf
    v_mfma_f32_16x16x32_bf16 v[244:247], v[160:163], v[232:235], 0
    v_add_f32_dpp v141, v250, v141 quad_perm:[2,2,2,2] row_mask:0xf bank_mask:0xf
    v_mov_b32_dpp v143, v236 quad_perm:[0,0,0,0] row_mask:0xf bank_mask:0xf
    v_add_f32_dpp v142, v253, v142 quad_perm:[1,1,1,1] row_mask:0xf bank_mask:0xf
    v_add_f32_dpp v141, v251, v141 quad_perm:[3,3,3,3] row_mask:0xf bank_mask:0xf
    v_mfma_f32_16x16x32_bf16 v[248:251], v[164:167], v[232:235], 0
    v_add_f32_dpp v142, v254, v142 quad_perm:[2,2,2,2] row_mask:0xf bank_mask:0xf
    v_mov_b32_dpp v156, v240 quad_perm:[0,0,0,0] row_mask:0xf bank_mask:0xf
    v_add_f32_dpp v143, v237, v143 quad_perm:[1,1,1,1] row_mask:0xf bank_mask:0xf
    v_add_f32_dpp v142, v255, v142 quad_perm:[3,3,3,3] row_mask:0xf bank_mask:0xf
    v_mfma_f32_16x16x32_bf16 v[252:255], v[168:171], v[232:235], 0
    v_add_f32_dpp v143, v238, v143 quad_perm:[2,2,2,2] row_mask:0xf bank_mask:0xf
    v_mov_b32_dpp v157, v244 quad_perm:[0,0,0,0] row_mask:0xf bank_mask:0xf
    v_add_f32_dpp v156, v241, v156 quad_perm:[1,1,1,1] row_mask:0xf bank_mask:0xf
    v_add_f32_dpp v143, v239, v143 quad_perm:[3,3,3,3] row_mask:0xf bank_mask:0xf
    v_mfma_f32_16x16x32_bf16 v[236:239], v[172:175], v[232:235], 0
    v_add_f32_dpp v156, v242, v156 quad_perm:[2,2,2,2] row_mask:0xf bank_mask:0xf
    v_mov_b32_dpp v158, v248 quad_perm:[0,0,0,0] row_mask:0xf bank_mask:0xf
    v_add_f32_dpp v157, v245, v157 quad_perm:[1,1,1,1] row_mask:0xf bank_mask:0xf
    v_add_f32_dpp v156, v243, v156 quad_perm:[3,3,3,3] row_mask:0xf bank_mask:0xf
    v_mfma_f32_16x16x32_bf16 v[240:243], v[176:179], v[232:235], 0
    v_add_f32_dpp v157, v246, v157 quad_perm:[2,2,2,2] row_mask:0xf bank_mask:0xf
    v_mov_b32_dpp v159, v252 quad_perm:[0,0,0,0] row_mask:0xf bank_mask:0xf
    v_add_f32_dpp v158, v249, v158 quad_perm:[1,1,1,1] row_mask:0xf bank_mask:0xf
    v_add_f32_dpp v157, v247, v157 quad_perm:[3,3,3,3] row_mask:0xf bank_mask:0xf
    v_mfma_f32_16x16x32_bf16 v[244:247], v[180:183], v[232:235], 0
    v_add_f32_dpp v158, v250, v158 quad_perm:[2,2,2,2] row_mask:0xf bank_mask:0xf
    v_mov_b32_dpp v172, v236 quad_perm:[0,0,0,0] row_mask:0xf bank_mask:0xf
    v_add_f32_dpp v159, v253, v159 quad_perm:[1,1,1,1] row_mask:0xf bank_mask:0xf
    v_add_f32_dpp v158, v251, v158 quad_perm:[3,3,3,3] row_mask:0xf bank_mask:0xf
    s_nop 0
    v_add_f32_dpp v159, v254, v159 quad_perm:[2,2,2,2] row_mask:0xf bank_mask:0xf
    v_mov_b32_dpp v173, v240 quad_perm:[0,0,0,0] row_mask:0xf bank_mask:0xf
    v_add_f32_dpp v172, v237, v172 quad_perm:[1,1,1,1] row_mask:0xf bank_mask:0xf
    v_add_f32_dpp v159, v255, v159 quad_perm:[3,3,3,3] row_mask:0xf bank_mask:0xf
    s_nop 0
    v_add_f32_dpp v172, v238, v172 quad_perm:[2,2,2,2] row_mask:0xf bank_mask:0xf
    v_mov_b32_dpp v174, v244 quad_perm:[0,0,0,0] row_mask:0xf bank_mask:0xf
    v_add_f32_dpp v173, v241, v173 quad_perm:[1,1,1,1] row_mask:0xf bank_mask:0xf
    v_add_f32_dpp v172, v239, v172 quad_perm:[3,3,3,3] row_mask:0xf bank_mask:0xf
    s_nop 0
    v_add_f32_dpp v173, v242, v173 quad_perm:[2,2,2,2] row_mask:0xf bank_mask:0xf
    v_add_f32_dpp v174, v245, v174 quad_perm:[1,1,1,1] row_mask:0xf bank_mask:0xf
    s_nop 0
    v_add_f32_dpp v173, v243, v173 quad_perm:[3,3,3,3] row_mask:0xf bank_mask:0xf
    v_add_f32_dpp v174, v246, v174 quad_perm:[2,2,2,2] row_mask:0xf bank_mask:0xf
    s_nop 1
    v_add_f32_dpp v174, v247, v174 quad_perm:[3,3,3,3] row_mask:0xf bank_mask:0xf
    v_add_f32 v159, s84, v159
    v_add_f32 v172, s85, v172
    v_add_f32 v173, s86, v173
    v_add_f32 v174, s87, v174
    v_max3_f32 v236, v12, v13, v14
    v_max3_f32 v236, v236, v15, v28
    v_max3_f32 v236, v236, v29, v30
    v_max3_f32 v236, v236, v31, v44
    v_max3_f32 v236, v236, v45, v46
    v_max3_f32 v236, v236, v47, v60
    v_max3_f32 v236, v236, v61, v62
    v_max3_f32 v236, v236, v63, v76
    v_max3_f32 v236, v236, v77, v78
    v_max3_f32 v236, v236, v79, v92
    v_max3_f32 v236, v236, v93, v94
    v_max3_f32 v236, v236, v95, v108
    v_max3_f32 v236, v236, v109, v110
    v_max3_f32 v236, v236, v111, v124
    v_max3_f32 v236, v236, v125, v126
    v_max3_f32 v236, v236, v127, v140
    v_max3_f32 v236, v236, v141, v142
    v_max3_f32 v236, v236, v143, v156
    v_max3_f32 v236, v236, v157, v158
    v_max3_f32 v236, v236, v159, v172
    v_max3_f32 v236, v236, v173, v174
    s_mov_b32 s14, 0x3e0293ee
    v_mov_b32 v239, v236
    s_nop 1
    v_permlane32_swap_b32 v239, v236
    v_max_f32 v236, v236, v239
    v_mov_b32 v239, v236
    s_nop 1
    v_permlane16_swap_b32 v239, v236
    v_max_f32 v236, v236, v239
    v_mul_f32 v236, s14, v236
    s_lshl_b32 s12, s9, 4
    v_lshlrev_b32 v11, 6, v2
    v_lshl_add_u32 v237, v1, 2, v11
    v_add_u32 v237, s12, v237
    ds_write_b32 v237, v236 offset:512
    buffer_load_dwordx4 v[68:71], v10, s[48:51], 0 offen offset:3072 nt
    v_add_u32 v10, s13, v10
    v_fma_f32 v12, v12, s14, -v236
    v_fma_f32 v13, v13, s14, -v236
    v_fma_f32 v14, v14, s14, -v236
    v_fma_f32 v15, v15, s14, -v236
    v_exp_f32 v12, v12
    v_exp_f32 v13, v13
    v_exp_f32 v14, v14
    v_exp_f32 v15, v15
    v_mov_b32 v238, v12
    v_add_f32 v238, v238, v13
    v_add_f32 v238, v238, v14
    v_add_f32 v238, v238, v15
    v_cvt_pk_bf16_f32 v12, v12, v12
    v_cvt_pk_bf16_f32 v13, v13, v13
    v_cvt_pk_bf16_f32 v14, v14, v14
    v_cvt_pk_bf16_f32 v15, v15, v15
    v_fma_f32 v28, v28, s14, -v236
    v_fma_f32 v29, v29, s14, -v236
    v_fma_f32 v30, v30, s14, -v236
    v_fma_f32 v31, v31, s14, -v236
    v_exp_f32 v28, v28
    v_exp_f32 v29, v29
    v_exp_f32 v30, v30
    v_exp_f32 v31, v31
    v_add_f32 v238, v238, v28
    v_add_f32 v238, v238, v29
    v_add_f32 v238, v238, v30
    v_add_f32 v238, v238, v31
    v_cvt_pk_bf16_f32 v28, v28, v28
    v_cvt_pk_bf16_f32 v29, v29, v29
    v_cvt_pk_bf16_f32 v30, v30, v30
    v_cvt_pk_bf16_f32 v31, v31, v31
    v_fma_f32 v44, v44, s14, -v236
    v_fma_f32 v45, v45, s14, -v236
    v_fma_f32 v46, v46, s14, -v236
    v_fma_f32 v47, v47, s14, -v236
    v_exp_f32 v44, v44
    v_exp_f32 v45, v45
    v_exp_f32 v46, v46
    v_exp_f32 v47, v47
    v_add_f32 v238, v238, v44
    v_add_f32 v238, v238, v45
    v_add_f32 v238, v238, v46
    v_add_f32 v238, v238, v47
    v_cvt_pk_bf16_f32 v44, v44, v44
    v_cvt_pk_bf16_f32 v45, v45, v45
    v_cvt_pk_bf16_f32 v46, v46, v46
    v_cvt_pk_bf16_f32 v47, v47, v47
    buffer_load_dwordx4 v[72:75], v10, s[48:51], 0 offen offset:0 nt
    v_fma_f32 v60, v60, s14, -v236
    v_fma_f32 v61, v61, s14, -v236
    v_fma_f32 v62, v62, s14, -v236
    v_fma_f32 v63, v63, s14, -v236
    v_exp_f32 v60, v60
    v_exp_f32 v61, v61
    v_exp_f32 v62, v62
    v_exp_f32 v63, v63
    v_add_f32 v238, v238, v60
    v_add_f32 v238, v238, v61
    v_add_f32 v238, v238, v62
    v_add_f32 v238, v238, v63
    v_cvt_pk_bf16_f32 v60, v60, v60
    v_cvt_pk_bf16_f32 v61, v61, v61
    v_cvt_pk_bf16_f32 v62, v62, v62
    v_cvt_pk_bf16_f32 v63, v63, v63
    v_fma_f32 v76, v76, s14, -v236
    v_fma_f32 v77, v77, s14, -v236
    v_fma_f32 v78, v78, s14, -v236
    v_fma_f32 v79, v79, s14, -v236
    v_exp_f32 v76, v76
    v_exp_f32 v77, v77
    v_exp_f32 v78, v78
    v_exp_f32 v79, v79
    v_add_f32 v238, v238, v76
    v_add_f32 v238, v238, v77
    v_add_f32 v238, v238, v78
    v_add_f32 v238, v238, v79
    v_cvt_pk_bf16_f32 v76, v76, v76
    v_cvt_pk_bf16_f32 v77, v77, v77
    v_cvt_pk_bf16_f32 v78, v78, v78
    v_cvt_pk_bf16_f32 v79, v79, v79
    v_fma_f32 v92, v92, s14, -v236
    v_fma_f32 v93, v93, s14, -v236
    v_fma_f32 v94, v94, s14, -v236
    v_fma_f32 v95, v95, s14, -v236
    v_exp_f32 v92, v92
    v_exp_f32 v93, v93
    v_exp_f32 v94, v94
    v_exp_f32 v95, v95
    v_add_f32 v238, v238, v92
    v_add_f32 v238, v238, v93
    v_add_f32 v238, v238, v94
    v_add_f32 v238, v238, v95
    v_cvt_pk_bf16_f32 v92, v92, v92
    v_cvt_pk_bf16_f32 v93, v93, v93
    v_cvt_pk_bf16_f32 v94, v94, v94
    v_cvt_pk_bf16_f32 v95, v95, v95
    buffer_load_dwordx4 v[80:83], v10, s[48:51], 0 offen offset:1024 nt
    v_fma_f32 v108, v108, s14, -v236
    v_fma_f32 v109, v109, s14, -v236
    v_fma_f32 v110, v110, s14, -v236
    v_fma_f32 v111, v111, s14, -v236
    v_exp_f32 v108, v108
    v_exp_f32 v109, v109
    v_exp_f32 v110, v110
    v_exp_f32 v111, v111
    v_add_f32 v238, v238, v108
    v_add_f32 v238, v238, v109
    v_add_f32 v238, v238, v110
    v_add_f32 v238, v238, v111
    v_cvt_pk_bf16_f32 v108, v108, v108
    v_cvt_pk_bf16_f32 v109, v109, v109
    v_cvt_pk_bf16_f32 v110, v110, v110
    v_cvt_pk_bf16_f32 v111, v111, v111
    v_fma_f32 v124, v124, s14, -v236
    v_fma_f32 v125, v125, s14, -v236
    v_fma_f32 v126, v126, s14, -v236
    v_fma_f32 v127, v127, s14, -v236
    v_exp_f32 v124, v124
    v_exp_f32 v125, v125
    v_exp_f32 v126, v126
    v_exp_f32 v127, v127
    v_add_f32 v238, v238, v124
    v_add_f32 v238, v238, v125
    v_add_f32 v238, v238, v126
    v_add_f32 v238, v238, v127
    v_cvt_pk_bf16_f32 v124, v124, v124
    v_cvt_pk_bf16_f32 v125, v125, v125
    v_cvt_pk_bf16_f32 v126, v126, v126
    v_cvt_pk_bf16_f32 v127, v127, v127
    v_fma_f32 v140, v140, s14, -v236
    v_fma_f32 v141, v141, s14, -v236
    v_fma_f32 v142, v142, s14, -v236
    v_fma_f32 v143, v143, s14, -v236
    v_exp_f32 v140, v140
    v_exp_f32 v141, v141
    v_exp_f32 v142, v142
    v_exp_f32 v143, v143
    v_add_f32 v238, v238, v140
    v_add_f32 v238, v238, v141
    v_add_f32 v238, v238, v142
    v_add_f32 v238, v238, v143
    v_cvt_pk_bf16_f32 v140, v140, v140
    v_cvt_pk_bf16_f32 v141, v141, v141
    v_cvt_pk_bf16_f32 v142, v142, v142
    v_cvt_pk_bf16_f32 v143, v143, v143
    buffer_load_dwordx4 v[84:87], v10, s[48:51], 0 offen offset:2048 nt
    v_fma_f32 v156, v156, s14, -v236
    v_fma_f32 v157, v157, s14, -v236
    v_fma_f32 v158, v158, s14, -v236
    v_fma_f32 v159, v159, s14, -v236
    v_exp_f32 v156, v156
    v_exp_f32 v157, v157
    v_exp_f32 v158, v158
    v_exp_f32 v159, v159
    v_add_f32 v238, v238, v156
    v_add_f32 v238, v238, v157
    v_add_f32 v238, v238, v158
    v_add_f32 v238, v238, v159
    v_cvt_pk_bf16_f32 v156, v156, v156
    v_cvt_pk_bf16_f32 v157, v157, v157
    v_cvt_pk_bf16_f32 v158, v158, v158
    v_cvt_pk_bf16_f32 v159, v159, v159
    v_fma_f32 v172, v172, s14, -v236
    v_fma_f32 v173, v173, s14, -v236
    v_fma_f32 v174, v174, s14, -v236
    v_exp_f32 v172, v172
    v_exp_f32 v173, v173
    v_exp_f32 v174, v174
    v_add_f32 v238, v238, v172
    v_add_f32 v238, v238, v173
    v_add_f32 v238, v238, v174
    v_cvt_pk_bf16_f32 v172, v172, v172
    v_cvt_pk_bf16_f32 v173, v173, v173
    v_cvt_pk_bf16_f32 v174, v174, v174
    ds_write_b32 v237, v238 offset:1536
    v_mov_b32 v232, 1
    v_mov_b32 v233, 0
    s_mov_b64 exec, 1
    ds_add_u32 v233, v232 offset:6664
    s_mov_b64 exec, -1
    v_and_b32 v244, v12, v4
    v_and_b32 v245, v12, v5
    v_and_b32 v246, v12, v6
    v_and_b32 v247, v12, v7
    s_waitcnt vmcnt(25)
    s_nop 0
    v_mfma_f32_16x16x32_bf16 v[240:243], v[244:247], v[184:187], 0
    v_and_b32 v248, v13, v4
    v_and_b32 v249, v13, v5
    v_and_b32 v250, v13, v6
    v_and_b32 v251, v13, v7
    s_waitcnt vmcnt(24)
    s_nop 0
    v_mfma_f32_16x16x32_bf16 v[240:243], v[248:251], v[188:191], v[240:243]
    v_and_b32 v244, v14, v4
    v_and_b32 v245, v14, v5
    v_and_b32 v246, v14, v6
    v_and_b32 v247, v14, v7
    s_waitcnt vmcnt(23)
    s_nop 0
    v_mfma_f32_16x16x32_bf16 v[240:243], v[244:247], v[192:195], v[240:243]
    v_and_b32 v248, v15, v4
    v_and_b32 v249, v15, v5
    v_and_b32 v250, v15, v6
    v_and_b32 v251, v15, v7
    s_waitcnt vmcnt(22)
    s_nop 0
    v_mfma_f32_16x16x32_bf16 v[240:243], v[248:251], v[196:199], v[240:243]
    v_and_b32 v244, v28, v4
    v_and_b32 v245, v28, v5
    v_and_b32 v246, v28, v6
    v_and_b32 v247, v28, v7
    s_waitcnt vmcnt(21)
    s_nop 0
    v_mfma_f32_16x16x32_bf16 v[240:243], v[244:247], v[200:203], v[240:243]
    v_and_b32 v248, v29, v4
    v_and_b32 v249, v29, v5
    v_and_b32 v250, v29, v6
    v_and_b32 v251, v29, v7
    s_waitcnt vmcnt(20)
    s_nop 0
    v_mfma_f32_16x16x32_bf16 v[240:243], v[248:251], v[204:207], v[240:243]
    v_and_b32 v244, v30, v4
    v_and_b32 v245, v30, v5
    v_and_b32 v246, v30, v6
    v_and_b32 v247, v30, v7
    s_waitcnt vmcnt(19)
    s_nop 0
    v_mfma_f32_16x16x32_bf16 v[240:243], v[244:247], v[208:211], v[240:243]
    v_and_b32 v248, v31, v4
    v_and_b32 v249, v31, v5
    v_and_b32 v250, v31, v6
    v_and_b32 v251, v31, v7
    s_waitcnt vmcnt(18)
    s_nop 0
    v_mfma_f32_16x16x32_bf16 v[240:243], v[248:251], v[212:215], v[240:243]
    v_and_b32 v244, v44, v4
    v_and_b32 v245, v44, v5
    v_and_b32 v246, v44, v6
    v_and_b32 v247, v44, v7
    s_waitcnt vmcnt(17)
    s_nop 0
    v_mfma_f32_16x16x32_bf16 v[240:243], v[244:247], v[216:219], v[240:243]
    v_and_b32 v248, v45, v4
    v_and_b32 v249, v45, v5
    v_and_b32 v250, v45, v6
    v_and_b32 v251, v45, v7
    s_waitcnt vmcnt(16)
    s_nop 0
    v_mfma_f32_16x16x32_bf16 v[240:243], v[248:251], v[220:223], v[240:243]
    v_and_b32 v244, v46, v4
    v_and_b32 v245, v46, v5
    v_and_b32 v246, v46, v6
    v_and_b32 v247, v46, v7
    s_waitcnt vmcnt(15)
    s_nop 0
    v_mfma_f32_16x16x32_bf16 v[240:243], v[244:247], v[224:227], v[240:243]
    v_and_b32 v248, v47, v4
    v_and_b32 v249, v47, v5
    v_and_b32 v250, v47, v6
    v_and_b32 v251, v47, v7
    s_waitcnt vmcnt(14)
    s_nop 0
    v_mfma_f32_16x16x32_bf16 v[240:243], v[248:251], v[228:231], v[240:243]
    v_and_b32 v244, v156, v4
    v_and_b32 v245, v156, v5
    v_and_b32 v246, v156, v6
    v_and_b32 v247, v156, v7
    s_waitcnt vmcnt(13)
    s_nop 0
    v_mfma_f32_16x16x32_bf16 v[240:243], v[244:247], v[16:19], v[240:243]
    v_and_b32 v248, v157, v4
    v_and_b32 v249, v157, v5
    v_and_b32 v250, v157, v6
    v_and_b32 v251, v157, v7
    s_waitcnt vmcnt(12)
    s_nop 0
    v_mfma_f32_16x16x32_bf16 v[240:243], v[248:251], v[20:23], v[240:243]
    v_and_b32 v244, v158, v4
    v_and_b32 v245, v158, v5
    v_and_b32 v246, v158, v6
    v_and_b32 v247, v158, v7
    s_waitcnt vmcnt(11)
    buffer_load_dwordx4 v[88:91], v10, s[48:51], 0 offen offset:3072 nt
    v_add_u32 v10, s13, v10
    v_mfma_f32_16x16x32_bf16 v[240:243], v[244:247], v[24:27], v[240:243]
    v_and_b32 v248, v159, v4
    v_and_b32 v249, v159, v5
    v_and_b32 v250, v159, v6
    v_and_b32 v251, v159, v7
    s_waitcnt vmcnt(11)
    s_nop 0
    v_mfma_f32_16x16x32_bf16 v[240:243], v[248:251], v[32:35], v[240:243]
    v_and_b32 v244, v172, v4
    v_and_b32 v245, v172, v5
    v_and_b32 v246, v172, v6
    v_and_b32 v247, v172, v7
    s_waitcnt vmcnt(10)
    s_nop 0
    v_mfma_f32_16x16x32_bf16 v[240:243], v[244:247], v[36:39], v[240:243]
    s_and_b32 s12, s5, 1
    s_lshl2_add_u32 s12, s12, s9
    s_and_b32 s86, s5, 6
    s_cmp_ge_u32 s5, 8
    s_cselect_b64 s[60:61], s[34:35], s[24:25]
    s_cselect_b32 s87, 0, 13
    s_cselect_b32 s88, 13, 3
    s_mov_b32 s62, 0x480000
    s_mov_b32 s63, 0x20000
    s_lshl3_add_u32 s59, s4, s86
    s_mul_i32 s59, s59, 36864
    s_lshl_b32 s89, s12, 7
    s_add_u32 s59, s59, s89
    s_add_u32 s92, s59, 36864
    s_andn2_b32 s58, s5, 1
    s_lshl4_add_u32 s58, s4, s58
    s_mul_i32 s58, s58, 4352
    s_lshl1_add_u32 s58, s89, s58
    s_add_u32 s58, s58, 270336
    s_lshl4_add_u32 s87, s4, s87
    s_mul_i32 s87, s87, 4352
    s_add_u32 s87, s87, 270336
    s_lshr_b32 s56, s86, 2
    s_lshl_b32 s56, s56, 6
    s_add_u32 s56, s56, s87
    s_lshl_b32 s57, s86, 7
    s_add_u32 s57, s57, s87
    v_lshrrev_b32 v216, 3, v0
    v_and_b32 v217, 7, v0
    v_mul_u32_u24 v224, 4608, v216
    v_lshl_add_u32 v224, v217, 4, v224
    v_cmp_gt_u32 s[80:81], s88, v217
    v_add_u32 v226, 8, v217
    v_cmp_gt_u32 s[82:83], s88, v226
    v_cndmask_b32 v225, 0, v217, s[80:81]
    s_nop 0
    v_cndmask_b32 v226, 0, v226, s[82:83]
    v_mul_u32_u24 v225, 4352, v225
    v_mul_u32_u24 v226, 4352, v226
    v_lshl_add_u32 v229, v216, 4, v225
    v_lshl_add_u32 v230, v216, 4, v226
    v_mov_b32 v227, 0xffffff00
    v_lshlrev_b32 v228, 4, v2
    v_lshl_add_u32 v228, v1, 7, v228
    v_and_b32 v248, v173, v4
    v_and_b32 v249, v173, v5
    v_and_b32 v250, v173, v6
    v_and_b32 v251, v173, v7
    s_waitcnt vmcnt(9)
    s_nop 0
    v_mfma_f32_16x16x32_bf16 v[240:243], v[248:251], v[40:43], v[240:243]
    v_and_b32 v244, v174, v4
    v_and_b32 v245, v174, v5
    v_and_b32 v246, v174, v6
    v_and_b32 v247, v174, v7
    s_waitcnt vmcnt(8)
    s_nop 0
    v_mfma_f32_16x16x32_bf16 v[240:243], v[244:247], v[48:51], v[240:243]
    v_and_b32 v248, v60, v4
    v_and_b32 v249, v60, v5
    v_and_b32 v250, v60, v6
    v_and_b32 v251, v60, v7
    s_waitcnt vmcnt(7)
    buffer_load_dwordx4 v[96:99], v10, s[48:51], 0 offen offset:0 nt
    v_mfma_f32_16x16x32_bf16 v[240:243], v[248:251], v[52:55], v[240:243]
    v_and_b32 v244, v61, v4
    v_and_b32 v245, v61, v5
    v_and_b32 v246, v61, v6
    v_and_b32 v247, v61, v7
    s_waitcnt vmcnt(7)
    buffer_load_dwordx4 v[100:103], v10, s[48:51], 0 offen offset:1024 nt
    v_mfma_f32_16x16x32_bf16 v[240:243], v[244:247], v[56:59], v[240:243]
    v_and_b32 v248, v62, v4
    v_and_b32 v249, v62, v5
    v_and_b32 v250, v62, v6
    v_and_b32 v251, v62, v7
    s_waitcnt vmcnt(7)
    buffer_load_dwordx4 v[104:107], v10, s[48:51], 0 offen offset:2048 nt
    v_mfma_f32_16x16x32_bf16 v[240:243], v[248:251], v[64:67], v[240:243]
    v_and_b32 v244, v63, v4
    v_and_b32 v245, v63, v5
    v_and_b32 v246, v63, v6
    v_and_b32 v247, v63, v7
    s_waitcnt vmcnt(7)
    buffer_load_dwordx4 v[112:115], v10, s[48:51], 0 offen offset:3072 nt
    v_add_u32 v10, s13, v10
    v_mfma_f32_16x16x32_bf16 v[240:243], v[244:247], v[68:71], v[240:243]
    v_and_b32 v248, v76, v4
    v_and_b32 v249, v76, v5
    v_and_b32 v250, v76, v6
    v_and_b32 v251, v76, v7
    s_waitcnt vmcnt(7)
    buffer_load_dwordx4 v[116:119], v10, s[48:51], 0 offen offset:0 nt
    v_mfma_f32_16x16x32_bf16 v[240:243], v[248:251], v[72:75], v[240:243]
    v_and_b32 v244, v77, v4
    v_and_b32 v245, v77, v5
    v_and_b32 v246, v77, v6
    v_and_b32 v247, v77, v7
    s_waitcnt vmcnt(7)
    buffer_load_dwordx4 v[120:123], v10, s[48:51], 0 offen offset:1024 nt
    v_mfma_f32_16x16x32_bf16 v[240:243], v[244:247], v[80:83], v[240:243]
    v_and_b32 v248, v78, v4
    v_and_b32 v249, v78, v5
    v_and_b32 v250, v78, v6
    v_and_b32 v251, v78, v7
    s_waitcnt vmcnt(7)
    buffer_load_dwordx4 v[128:131], v10, s[48:51], 0 offen offset:2048 nt
    v_mfma_f32_16x16x32_bf16 v[240:243], v[248:251], v[84:87], v[240:243]
    v_and_b32 v244, v79, v4
    v_and_b32 v245, v79, v5
    v_and_b32 v246, v79, v6
    v_and_b32 v247, v79, v7
    s_waitcnt vmcnt(7)
    buffer_load_dwordx4 v[132:135], v10, s[48:51], 0 offen offset:3072 nt
    v_add_u32 v10, s13, v10
    v_mfma_f32_16x16x32_bf16 v[240:243], v[244:247], v[88:91], v[240:243]
    v_and_b32 v248, v92, v4
    v_and_b32 v249, v92, v5
    v_and_b32 v250, v92, v6
    v_and_b32 v251, v92, v7
    s_waitcnt vmcnt(7)
    buffer_load_dwordx4 v[136:139], v10, s[48:51], 0 offen offset:0 nt
    v_mfma_f32_16x16x32_bf16 v[240:243], v[248:251], v[96:99], v[240:243]
    v_and_b32 v244, v93, v4
    v_and_b32 v245, v93, v5
    v_and_b32 v246, v93, v6
    v_and_b32 v247, v93, v7
    s_waitcnt vmcnt(7)
    buffer_load_dwordx4 v[144:147], v10, s[48:51], 0 offen offset:1024 nt
    v_mfma_f32_16x16x32_bf16 v[240:243], v[244:247], v[100:103], v[240:243]
    v_and_b32 v248, v94, v4
    v_and_b32 v249, v94, v5
    v_and_b32 v250, v94, v6
    v_and_b32 v251, v94, v7
    s_waitcnt vmcnt(7)
    buffer_load_dwordx4 v[148:151], v10, s[48:51], 0 offen offset:2048 nt
    v_mfma_f32_16x16x32_bf16 v[240:243], v[248:251], v[104:107], v[240:243]
    v_and_b32 v244, v95, v4
    v_and_b32 v245, v95, v5
    v_and_b32 v246, v95, v6
    v_and_b32 v247, v95, v7
    s_waitcnt vmcnt(7)
    buffer_load_dwordx4 v[152:155], v10, s[48:51], 0 offen offset:3072 nt
    v_add_u32 v10, s13, v10
    v_mfma_f32_16x16x32_bf16 v[240:243], v[244:247], v[112:115], v[240:243]
    s_mov_b64 exec, 1
    ds_add_u32 v233, v232 offset:6680
    s_mov_b64 exec, -1
    s_mov_b32 s14, 1600000
L_lw7:
    ds_read_b32 v234, v233 offset:6680
    s_sub_u32 s14, s14, 1
    s_cbranch_scc1 L_lx7
    s_waitcnt lgkmcnt(0)
    v_cmp_gt_u32 vcc, 4, v234
    s_cbranch_vccnz L_lw7
L_lx7:
    v_and_b32 v248, v108, v4
    v_and_b32 v249, v108, v5
    v_and_b32 v250, v108, v6
    v_and_b32 v251, v108, v7
    s_waitcnt vmcnt(7)
    buffer_load_dwordx4 v[160:163], v10, s[48:51], 0 offen offset:0 nt
    v_mfma_f32_16x16x32_bf16 v[240:243], v[248:251], v[116:119], v[240:243]
    v_and_b32 v244, v109, v4
    v_and_b32 v245, v109, v5
    v_and_b32 v246, v109, v6
    v_and_b32 v247, v109, v7
    s_waitcnt vmcnt(7)
    buffer_load_dwordx4 v[164:167], v10, s[48:51], 0 offen offset:1024 nt
    v_mfma_f32_16x16x32_bf16 v[240:243], v[244:247], v[120:123], v[240:243]
    v_and_b32 v248, v110, v4
    v_and_b32 v249, v110, v5
    v_and_b32 v250, v110, v6
    v_and_b32 v251, v110, v7
    s_waitcnt vmcnt(7)
    buffer_load_dwordx4 v[168:171], v10, s[48:51], 0 offen offset:2048 nt
    v_mfma_f32_16x16x32_bf16 v[240:243], v[248:251], v[128:131], v[240:243]
    v_and_b32 v244, v111, v4
    v_and_b32 v245, v111, v5
    v_and_b32 v246, v111, v6
    v_and_b32 v247, v111, v7
    s_waitcnt vmcnt(7)
    buffer_load_dwordx4 v[176:179], v10, s[48:51], 0 offen offset:3072 nt
    v_mfma_f32_16x16x32_bf16 v[240:243], v[244:247], v[132:135], v[240:243]
    v_and_b32 v248, v124, v4
    v_and_b32 v249, v124, v5
    v_and_b32 v250, v124, v6
    v_and_b32 v251, v124, v7
    s_waitcnt vmcnt(7)
    s_mov_b64 exec, 1
    ds_add_u32 v233, v232 offset:6668
    s_mov_b64 exec, -1
    buffer_load_dwordx4 v[216:219], v225, s[52:55], s56 offen offset:1024 sc1
    buffer_load_dwordx4 v[220:223], v226, s[52:55], s56 offen offset:1024 sc1
    v_mfma_f32_16x16x32_bf16 v[240:243], v[248:251], v[136:139], v[240:243]
    v_and_b32 v244, v125, v4
    v_and_b32 v245, v125, v5
    v_and_b32 v246, v125, v6
    v_and_b32 v247, v125, v7
    s_waitcnt vmcnt(8)
    s_nop 0
    v_mfma_f32_16x16x32_bf16 v[240:243], v[244:247], v[144:147], v[240:243]
    v_and_b32 v248, v126, v4
    v_and_b32 v249, v126, v5
    v_and_b32 v250, v126, v6
    v_and_b32 v251, v126, v7
    s_waitcnt vmcnt(7)
    s_nop 0
    v_mfma_f32_16x16x32_bf16 v[240:243], v[248:251], v[148:151], v[240:243]
    v_and_b32 v244, v127, v4
    v_and_b32 v245, v127, v5
    v_and_b32 v246, v127, v6
    v_and_b32 v247, v127, v7
    s_waitcnt vmcnt(6)
    s_nop 0
    v_mfma_f32_16x16x32_bf16 v[240:243], v[244:247], v[152:155], v[240:243]
    v_and_b32 v248, v140, v4
    v_and_b32 v249, v140, v5
    v_and_b32 v250, v140, v6
    v_and_b32 v251, v140, v7
    s_waitcnt vmcnt(5)
    buffer_load_dwordx4 v[184:187], v224, s[60:63], s59 offen offset:0 nt
    v_mfma_f32_16x16x32_bf16 v[240:243], v[248:251], v[160:163], v[240:243]
    v_and_b32 v244, v141, v4
    v_and_b32 v245, v141, v5
    v_and_b32 v246, v141, v6
    v_and_b32 v247, v141, v7
    s_waitcnt vmcnt(5)
    buffer_load_dwordx4 v[188:191], v224, s[60:63], s59 offen offset:1152 nt
    v_mfma_f32_16x16x32_bf16 v[240:243], v[244:247], v[164:167], v[240:243]
    v_and_b32 v248, v142, v4
    v_and_b32 v249, v142, v5
    v_and_b32 v250, v142, v6
    v_and_b32 v251, v142, v7
    s_waitcnt vmcnt(5)
    buffer_load_dwordx4 v[192:195], v224, s[60:63], s59 offen offset:2304 nt
    v_mfma_f32_16x16x32_bf16 v[240:243], v[248:251], v[168:171], v[240:243]
    v_and_b32 v244, v143, v4
    v_and_b32 v245, v143, v5
    v_and_b32 v246, v143, v6
    v_and_b32 v247, v143, v7
    s_waitcnt vmcnt(5)
    buffer_load_dwordx4 v[196:199], v224, s[60:63], s59 offen offset:3456 nt
    v_mfma_f32_16x16x32_bf16 v[240:243], v[244:247], v[176:179], v[240:243]
    s_nop 7
    ds_write_b128 v8, v[240:243] offset:2560
    s_mov_b64 exec, 1
    ds_add_u32 v233, v232 offset:6656
    s_mov_b64 exec, -1
    s_waitcnt vmcnt(4)
L_st_chk0:
    s_mov_b32 s14, 200040
    s_branch L_st_chk
L_poll_st:
    buffer_load_dwordx4 v[216:219], v225, s[52:55], s56 offen offset:1024 sc1
    buffer_load_dwordx4 v[220:223], v226, s[52:55], s56 offen offset:1024 sc1
    s_waitcnt vmcnt(0)
L_st_chk:
    v_xor_b32 v216, s42, v216
    v_xor_b32 v217, s93, v217
    v_xor_b32 v218, s94, v218
    v_xor_b32 v219, s95, v219
    v_xor_b32 v220, s42, v220
    v_xor_b32 v221, s93, v221
    v_xor_b32 v222, s94, v222
    v_xor_b32 v223, s95, v223
    v_or3_b32 v96, v216, v217, v218
    v_or3_b32 v96, v219, v220, v96
    v_or3_b32 v96, v221, v222, v96
    v_or_b32 v96, v223, v96
    v_and_b32 v96, 0xff, v96
    v_cmp_ne_u32 vcc, 0, v96
    s_cbranch_vccz L_st_ok
    s_sub_u32 s14, s14, 1
    s_cmp_gt_u32 s14, 200000
    s_cselect_b32 s13, 0, 2097152
    s_xor_b32 s56, s56, s13
    s_cmp_lg_u32 s14, 0
    s_cbranch_scc1 L_poll_st
L_st_ok:
    v_max_f32 v96, v216, v220
    s_nop 1
    v_max_f32_dpp v96, v96, v96 quad_perm:[1,0,3,2] row_mask:0xf bank_mask:0xf
    s_nop 1
    v_max_f32_dpp v96, v96, v96 quad_perm:[2,3,0,1] row_mask:0xf bank_mask:0xf
    s_nop 1
    v_max_f32_dpp v96, v96, v96 row_half_mirror row_mask:0xf bank_mask:0xf
    v_sub_f32 v216, v216, v96
    v_sub_f32 v220, v220, v96
    v_exp_f32 v216, v216
    v_exp_f32 v220, v220
    v_cndmask_b32 v216, 0, v216, s[80:81]
    v_cndmask_b32 v220, 0, v220, s[82:83]
    v_mul_f32 v217, v216, v217
    v_fmac_f32 v217, v220, v221
    s_nop 1
    v_add_f32_dpp v217, v217, v217 quad_perm:[1,0,3,2] row_mask:0xf bank_mask:0xf
    s_nop 1
    v_add_f32_dpp v217, v217, v217 quad_perm:[2,3,0,1] row_mask:0xf bank_mask:0xf
    s_nop 1
    v_add_f32_dpp v217, v217, v217 row_half_mirror row_mask:0xf bank_mask:0xf
    v_rcp_f32 v217, v217
    s_nop 0
    v_mul_f32 v216, v216, v217
    v_mul_f32 v220, v220, v217
    s_mov_b32 s14, 200064
    s_waitcnt vmcnt(8)
    v_mov_b32 v97, 0
    s_mov_b32 s14, 1600000
L_lw8:
    ds_read_b32 v96, v97 offset:6676
    s_sub_u32 s14, s14, 1
    s_cbranch_scc1 L_lx8
    s_waitcnt lgkmcnt(0)
    v_cmp_gt_u32 vcc, 1, v96
    s_cbranch_vccnz L_lw8
L_lx8:
    s_mov_b32 s14, 200064
    s_mov_b64 s[16:17], -1
    s_mov_b64 s[18:19], -1
    buffer_load_dwordx4 v[12:15], v229, s[52:55], s57 offen sc1
    buffer_load_dwordx4 v[16:19], v229, s[52:55], s57 offen offset:128 sc1
    buffer_load_dwordx4 v[20:23], v230, s[52:55], s57 offen sc1
    buffer_load_dwordx4 v[24:27], v230, s[52:55], s57 offen offset:128 sc1
    buffer_load_dwordx4 v[200:203], v224, s[60:63], s92 offen offset:0 nt
    buffer_load_dwordx4 v[204:207], v224, s[60:63], s92 offen offset:1152 nt
    buffer_load_dwordx4 v[208:211], v224, s[60:63], s92 offen offset:2304 nt
    buffer_load_dwordx4 v[212:215], v224, s[60:63], s92 offen offset:3456 nt
    s_waitcnt vmcnt(4)
    s_branch L_o_chk
L_poll_o:
    s_waitcnt vmcnt(2)
    s_mov_b64 exec, s[16:17]
    s_cbranch_execz L_oa0
    buffer_load_dwordx4 v[12:15], v229, s[52:55], s57 offen sc1
    buffer_load_dwordx4 v[16:19], v229, s[52:55], s57 offen offset:128 sc1
L_oa0:
    s_mov_b64 exec, s[18:19]
    s_cbranch_execz L_oa1
    buffer_load_dwordx4 v[20:23], v230, s[52:55], s57 offen sc1
    buffer_load_dwordx4 v[24:27], v230, s[52:55], s57 offen offset:128 sc1
L_oa1:
    s_waitcnt vmcnt(0)
L_o_chk:
    s_mov_b64 exec, s[16:17]
    s_cbranch_execz L_ob0
    v_xor_b32 v12, s42, v12
    v_xor_b32 v13, s93, v13
    v_xor_b32 v14, s94, v14
    v_xor_b32 v15, s95, v15
    v_xor_b32 v16, s42, v16
    v_xor_b32 v17, s93, v17
    v_xor_b32 v18, s94, v18
    v_xor_b32 v19, s95, v19
    v_or3_b32 v96, v12, v13, v14
    v_or3_b32 v96, v15, v16, v96
    v_or3_b32 v96, v17, v18, v96
    v_or_b32 v96, v19, v96
    v_and_b32 v96, 0xff, v96
    v_cmp_ne_u32 s[16:17], 0, v96
L_ob0:
    s_mov_b64 exec, s[18:19]
    s_cbranch_execz L_ob1
    v_xor_b32 v20, s42, v20
    v_xor_b32 v21, s93, v21
    v_xor_b32 v22, s94, v22
    v_xor_b32 v23, s95, v23
    v_xor_b32 v24, s42, v24
    v_xor_b32 v25, s93, v25
    v_xor_b32 v26, s94, v26
    v_xor_b32 v27, s95, v27
    v_or3_b32 v96, v20, v21, v22
    v_or3_b32 v96, v23, v24, v96
    v_or3_b32 v96, v25, v26, v96
    v_or_b32 v96, v27, v96
    v_and_b32 v96, 0xff, v96
    v_cmp_ne_u32 s[18:19], 0, v96
L_ob1:
    s_mov_b64 exec, -1
    s_or_b64 vcc, s[16:17], s[18:19]
    s_cbranch_scc0 L_o_ok
    s_sub_u32 s14, s14, 1
    s_cmp_gt_u32 s14, 200000
    s_cselect_b32 s13, 0, 2097152
    s_xor_b32 s57, s57, s13
    s_cmp_lg_u32 s14, 0
    s_cbranch_scc1 L_poll_o
L_o_ok:
    v_mul_f32 v28, v216, v12
    v_mul_f32 v29, v216, v13
    v_mul_f32 v30, v216, v14
    v_mul_f32 v31, v216, v15
    v_mul_f32 v32, v216, v16
    v_mul_f32 v33, v216, v17
    v_mul_f32 v34, v216, v18
    v_mul_f32 v35, v216, v19
    v_fmac_f32 v28, v220, v20
    v_fmac_f32 v29, v220, v21
    v_fmac_f32 v30, v220, v22
    v_fmac_f32 v31, v220, v23
    v_fmac_f32 v32, v220, v24
    v_fmac_f32 v33, v220, v25
    v_fmac_f32 v34, v220, v26
    v_fmac_f32 v35, v220, v27
    v_add_f32_dpp v28, v28, v28 quad_perm:[1,0,3,2] row_mask:0xf bank_mask:0xf
    v_add_f32_dpp v29, v29, v29 quad_perm:[1,0,3,2] row_mask:0xf bank_mask:0xf
    v_add_f32_dpp v30, v30, v30 quad_perm:[1,0,3,2] row_mask:0xf bank_mask:0xf
    v_add_f32_dpp v31, v31, v31 quad_perm:[1,0,3,2] row_mask:0xf bank_mask:0xf
    v_add_f32_dpp v32, v32, v32 quad_perm:[1,0,3,2] row_mask:0xf bank_mask:0xf
    v_add_f32_dpp v33, v33, v33 quad_perm:[1,0,3,2] row_mask:0xf bank_mask:0xf
    v_add_f32_dpp v34, v34, v34 quad_perm:[1,0,3,2] row_mask:0xf bank_mask:0xf
    v_add_f32_dpp v35, v35, v35 quad_perm:[1,0,3,2] row_mask:0xf bank_mask:0xf
    v_add_f32_dpp v28, v28, v28 quad_perm:[2,3,0,1] row_mask:0xf bank_mask:0xf
    v_add_f32_dpp v29, v29, v29 quad_perm:[2,3,0,1] row_mask:0xf bank_mask:0xf
    v_add_f32_dpp v30, v30, v30 quad_perm:[2,3,0,1] row_mask:0xf bank_mask:0xf
    v_add_f32_dpp v31, v31, v31 quad_perm:[2,3,0,1] row_mask:0xf bank_mask:0xf
    v_add_f32_dpp v32, v32, v32 quad_perm:[2,3,0,1] row_mask:0xf bank_mask:0xf
    v_add_f32_dpp v33, v33, v33 quad_perm:[2,3,0,1] row_mask:0xf bank_mask:0xf
    v_add_f32_dpp v34, v34, v34 quad_perm:[2,3,0,1] row_mask:0xf bank_mask:0xf
    v_add_f32_dpp v35, v35, v35 quad_perm:[2,3,0,1] row_mask:0xf bank_mask:0xf
    v_add_f32_dpp v28, v28, v28 row_half_mirror row_mask:0xf bank_mask:0xf
    v_add_f32_dpp v29, v29, v29 row_half_mirror row_mask:0xf bank_mask:0xf
    v_add_f32_dpp v30, v30, v30 row_half_mirror row_mask:0xf bank_mask:0xf
    v_add_f32_dpp v31, v31, v31 row_half_mirror row_mask:0xf bank_mask:0xf
    v_add_f32_dpp v32, v32, v32 row_half_mirror row_mask:0xf bank_mask:0xf
    v_add_f32_dpp v33, v33, v33 row_half_mirror row_mask:0xf bank_mask:0xf
    v_add_f32_dpp v34, v34, v34 row_half_mirror row_mask:0xf bank_mask:0xf
    v_add_f32_dpp v35, v35, v35 row_half_mirror row_mask:0xf bank_mask:0xf
    v_cvt_pk_bf16_f32 v28, v28, v28
    v_and_b32 v40, v28, v4
    v_and_b32 v41, v28, v5
    v_and_b32 v42, v28, v6
    v_and_b32 v43, v28, v7
    v_cvt_pk_bf16_f32 v29, v29, v29
    v_and_b32 v44, v29, v4
    v_mfma_f32_16x16x32_bf16 v[72:75], v[40:43], v[184:187], 0
    v_and_b32 v45, v29, v5
    v_and_b32 v46, v29, v6
    v_and_b32 v47, v29, v7
    v_cvt_pk_bf16_f32 v30, v30, v30
    v_and_b32 v48, v30, v4
    v_mfma_f32_16x16x32_bf16 v[72:75], v[44:47], v[188:191], v[72:75]
    v_and_b32 v49, v30, v5
    v_and_b32 v50, v30, v6
    v_and_b32 v51, v30, v7
    v_cvt_pk_bf16_f32 v31, v31, v31
    v_and_b32 v52, v31, v4
    v_mfma_f32_16x16x32_bf16 v[72:75], v[48:51], v[192:195], v[72:75]
    v_and_b32 v53, v31, v5
    v_and_b32 v54, v31, v6
    v_and_b32 v55, v31, v7
    v_cvt_pk_bf16_f32 v32, v32, v32
    v_and_b32 v56, v32, v4
    v_mfma_f32_16x16x32_bf16 v[72:75], v[52:55], v[196:199], v[72:75]
    v_and_b32 v57, v32, v5
    v_and_b32 v58, v32, v6
    v_and_b32 v59, v32, v7
    v_cvt_pk_bf16_f32 v33, v33, v33
    v_and_b32 v60, v33, v4
    s_waitcnt vmcnt(3)
    v_mfma_f32_16x16x32_bf16 v[72:75], v[56:59], v[200:203], v[72:75]
    v_and_b32 v61, v33, v5
    v_and_b32 v62, v33, v6
    v_and_b32 v63, v33, v7
    v_cvt_pk_bf16_f32 v34, v34, v34
    v_and_b32 v64, v34, v4
    s_waitcnt vmcnt(2)
    v_mfma_f32_16x16x32_bf16 v[72:75], v[60:63], v[204:207], v[72:75]
    v_and_b32 v65, v34, v5
    v_and_b32 v66, v34, v6
    v_and_b32 v67, v34, v7
    v_cvt_pk_bf16_f32 v35, v35, v35
    v_and_b32 v68, v35, v4
    s_waitcnt vmcnt(1)
    v_mfma_f32_16x16x32_bf16 v[72:75], v[64:67], v[208:211], v[72:75]
    v_and_b32 v69, v35, v5
    v_and_b32 v70, v35, v6
    v_and_b32 v71, v35, v7
    s_waitcnt vmcnt(0)
    s_nop 0
    v_mfma_f32_16x16x32_bf16 v[72:75], v[68:71], v[212:215], v[72:75]
    s_mov_b64 s[90:91], 0x00ff00ff
    s_nop 6
    v_permlane32_swap_b32 v72, v76
    v_permlane32_swap_b32 v73, v77
    v_permlane32_swap_b32 v74, v78
    v_permlane32_swap_b32 v75, v79
    v_add_f32_dpp v72, v76, v72 row_ror:8 row_mask:0xf bank_mask:0xf
    v_add_f32_dpp v73, v77, v73 row_ror:8 row_mask:0xf bank_mask:0xf
    v_add_f32_dpp v74, v78, v74 row_ror:8 row_mask:0xf bank_mask:0xf
    v_add_f32_dpp v75, v79, v75 row_ror:8 row_mask:0xf bank_mask:0xf
    v_and_or_b32 v72, v72, v227, s42
    v_and_or_b32 v73, v73, v227, s93
    v_and_or_b32 v74, v74, v227, s94
    v_and_or_b32 v75, v75, v227, s95
    s_mov_b64 exec, s[90:91]
    buffer_store_dwordx4 v[72:75], v228, s[52:55], s58 offen offset:1280 sc1
L_fin:
    s_barrier
L_end:
    s_endpgm
.section .rodata,"a"
.p2align 6
.amdhsa_kernel concat_heads__sliding_block_cached__gqa_block_cached__decode_kernel
  .amdhsa_next_free_vgpr 256
  .amdhsa_next_free_sgpr 96
  .amdhsa_accum_offset 256
  .amdhsa_group_segment_fixed_size 0
  .amdhsa_kernarg_size 104
  .amdhsa_user_sgpr_count 2
  .amdhsa_user_sgpr_kernarg_segment_ptr 1
  .amdhsa_system_sgpr_workgroup_id_x 1
.end_amdhsa_kernel
```
